```python
import torch

def _softmax(x, axis=-1):
    return torch.softmax(x, dim=axis)
def _gelu(x):
    return torch.nn.functional.gelu(x, approximate="tanh")
def _silu(x):
    return torch.nn.functional.silu(x)
def _sigmoid(x):
    return torch.sigmoid(x)
def _layernorm(x, axis=-1, eps=1e-5):
    m = x.mean(dim=axis, keepdim=True)
    v = x.var(dim=axis, keepdim=True, unbiased=False)
    return (x - m) / torch.sqrt(v + eps)
def _scatter_add(tgt, idx, src, axis=0):
    return tgt.clone().index_add_(axis, idx, src)
def _segment_sum(src, seg, n):
    out = torch.zeros((n,) + src.shape[1:], dtype=src.dtype)
    return out.index_add_(0, seg, src)
def _pad(x, pw):
    flat = tuple(v for pair in reversed(pw) for v in pair)
    return torch.nn.functional.pad(x, flat)

kernel_name = 'gated_mix__softmax_full_mha__dense_activation_silu__prompt'

def setup_inputs():

    _w = (lambda a: (lambda t: t.to(torch.bfloat16) if t.is_floating_point() else t)(torch.as_tensor(a)))
    def _A_setup():
        B, S, D = 1, 2048, 640
        return {
            "x": _w((lambda *s: torch.randn(*s, dtype=torch.bfloat16) * 0.1)(B, S, D)),
            "wqkv": _w((lambda *s: torch.randn(*s, dtype=torch.bfloat16) * 0.4)(D, 3 * D)),
            "wo": _w((lambda *s: torch.randn(*s, dtype=torch.bfloat16) * 0.2)(D, D)),
        }
    _A_in = _A_setup()

    def _B_setup():
        B, S, D, F = 1, 2048, 640, 1536
        return {
            "x": _w((lambda *s: torch.randn(*s, dtype=torch.bfloat16) * 0.1)(B, S, D)),
            "w1": _w((lambda *s: torch.randn(*s, dtype=torch.bfloat16) * 3.2)(D, F) * (D ** -0.5)),
            "w2": _w((lambda *s: torch.randn(*s, dtype=torch.bfloat16) * 3.2)(F, D) * (F ** -0.5)),
        }
    _B_in = _B_setup()

    return {
        "A_x": _A_in["x"],
        "A_wqkv": _A_in["wqkv"],
        "A_wo": _A_in["wo"],
        "B_x": _B_in["x"],
        "B_w1": _B_in["w1"],
        "B_w2": _B_in["w2"],
        "gate_w": _w((lambda *s: torch.randn(*s, dtype=torch.bfloat16) * 0.1)(640) * 16.0),
    }

def reference(A_x, A_wqkv, A_wo, B_x, B_w1, B_w2, gate_w):
    def _A_ref(x, wqkv, wo):
        B, S, D = x.shape
        H = 32; Dh = D // H
        qkv = (lambda x, *d: x.permute(*d))((x @ wqkv).reshape(B, S, 3, H, Dh), 2, 0, 3, 1, 4)
        q, k, v = qkv[0], qkv[1], qkv[2]
        scale = Dh ** -0.5
        scores = torch.einsum("bhqd,bhkd->bhqk", q, k) * scale
        p = _softmax(scores, axis=-1)
        o = torch.einsum("bhqk,bhkd->bhqd", p, v)
        return (lambda x, *d: x.permute(*d))(o, 0, 2, 1, 3).reshape(B, S, D) @ wo

    def _B_ref(x, w1, w2):
        h = torch.einsum("bsd,df->bsf", x, w1)
        h = _silu(h)
        out = torch.einsum("bsf,fd->bsd", h, w2)
        return out

    x = A_x
    g = _sigmoid((x * gate_w).sum(-1, keepdims=True))
    a = _A_ref(x, A_wqkv, A_wo)
    b = _B_ref(x, B_w1, B_w2)
    return g * a + (1 - g) * b
```

```asm
; @launch kernel=gm_fused_kernel grid=(256,1,1) block=(768,1,1) lds=163840
.amdgcn_target "amdgcn-amd-amdhsa--gfx950"
.text
.globl gm_fused_kernel
.p2align 8
.type gm_fused_kernel,@function
gm_fused_kernel:
    s_cmp_ge_u32 s2, 256
    s_cbranch_scc1 L_end
    v_and_b32 v1, 63, v0
    v_lshrrev_b32 v6, 6, v0
    s_nop 0
    v_readfirstlane_b32 s40, v6
    s_cmp_lg_u32 s40, 4
    s_cbranch_scc1 L_args
    v_lshlrev_b32 v6, 2, v1
    v_add_u32 v6, 163584, v6
    v_mov_b32 v7, 0
    ds_write_b32 v6, v7
    s_waitcnt lgkmcnt(0)
L_args:
    s_load_dwordx16 s[4:19], s[0:1], 0
    s_load_dwordx4 s[20:23], s[0:1], 64
    s_and_b32 s66, s2, 1
    s_bfe_u32 s42, s2, 0x30003
    s_bfe_u32 s67, s2, 0x20001
    s_lshr_b32 s43, s2, 6
    s_lshl1_add_u32 s66, s42, s66
    s_lshl2_add_u32 s67, s43, s67
    s_mul_i32 s42, s42, 4
    s_mul_i32 s43, s43, 1
    s_add_u32 s93, s42, s43
    s_mul_i32 s42, s93, 205
    s_lshr_b32 s42, s42, 11
    s_mul_i32 s42, s42, 10
    s_sub_u32 s93, s93, s42
    s_barrier
    s_cmp_ge_u32 s40, 4
    s_cbranch_scc1 L_compute
    s_setprio 3
    v_mov_b32 v20, 0
    v_mov_b32 v21, 0
    v_mov_b32 v22, 0
    v_lshrrev_b32 v24, 4, v1
    v_and_b32 v26, 7, v1
    v_xor_b32 v25, v24, v26
    v_lshrrev_b32 v26, 3, v1
    v_and_b32 v27, 4, v26
    v_add_u32 v26, v26, v27
    v_mul_u32_u24 v26, 1280, v26
    v_lshl_add_u32 v16, v25, 4, v26
    v_xor_b32 v17, 64, v16
    v_lshlrev_b32 v25, 1, v24
    v_and_b32 v26, 15, v1
    v_xor_b32 v25, v25, v26
    v_mul_u32_u24 v26, 3840, v24
    v_lshl_add_u32 v18, v25, 4, v26
    v_xor_b32 v19, 128, v18
    s_lshl_b32 s54, s40, 15
    s_add_u32 s54, s54, 32512
    s_mul_i32 s55, s66, 163840
    s_mov_b32 s69, s40
    s_lshl_b32 s42, s40, 2
    s_add_u32 s42, s42, 163584
    v_mov_b32 v14, s42
    v_mov_b32 v15, 1
    s_waitcnt lgkmcnt(0)
    s_mov_b32 s32, s4
    s_mov_b32 s33, s5
    s_mov_b32 s34, 2621440
    s_mov_b32 s35, 0x00020000
    s_mov_b32 s36, s6
    s_mov_b32 s37, s7
    s_mov_b32 s38, 2457600
    s_mov_b32 s39, 0x00020000
    s_mov_b32 s28, s12
    s_mov_b32 s29, s13
    s_mov_b32 s30, 1966080
    s_mov_b32 s31, 0x00020000
    s_cmp_lt_u32 s40, 1
    s_cbranch_scc1 L_stage
    s_sleep 6
    s_cmp_lt_u32 s40, 2
    s_cbranch_scc1 L_stage
    s_sleep 6
    s_cmp_lt_u32 s40, 3
    s_cbranch_scc1 L_stage
    s_sleep 6
    s_branch L_stage
L_next:
    s_mov_b32 s46, 0x40000
L_poll1:
    ds_read_b32 v10, v14 offset:96
    s_waitcnt lgkmcnt(0)
    v_readfirstlane_b32 s42, v10
    s_cmp_eq_u32 s42, 4
    s_cbranch_scc1 L_got1
    s_sleep 1
    s_sub_u32 s46, s46, 1
    s_cmp_lg_u32 s46, 0
    s_cbranch_scc1 L_poll1
L_got1:
L_stage:
    s_sub_u32 s42, s69, 4
    s_sub_u32 s43, s69, 14
    s_cmp_lt_u32 s69, 14
    s_cselect_b32 s42, s42, s43
    s_cmp_lt_u32 s69, 10
    s_cselect_b32 s56, s69, s42
    s_add_u32 s56, s56, s93
    s_sub_u32 s42, s56, 10
    s_min_u32 s56, s56, s42
    s_sub_u32 s43, s69, 10
    s_cmp_lt_u32 s43, 4
    s_cbranch_scc1 L_w1
    s_lshl_b32 s57, s56, 7
    s_add_u32 s57, s57, s55
    s_add_u32 m0, s54, 0
    s_add_u32 s42, s57, 0
    buffer_load_dwordx4 v16, s[32:35], s42 offen lds
    s_add_u32 m0, s54, 1024
    s_add_u32 s42, s57, 20480
    buffer_load_dwordx4 v17, s[32:35], s42 offen lds
    s_add_u32 m0, s54, 2048
    s_add_u32 s42, s57, 5120
    buffer_load_dwordx4 v16, s[32:35], s42 offen lds
    s_add_u32 m0, s54, 3072
    s_add_u32 s42, s57, 25600
    buffer_load_dwordx4 v17, s[32:35], s42 offen lds
    s_add_u32 m0, s54, 4096
    s_add_u32 s42, s57, 40960
    buffer_load_dwordx4 v16, s[32:35], s42 offen lds
    s_add_u32 m0, s54, 5120
    s_add_u32 s42, s57, 61440
    buffer_load_dwordx4 v17, s[32:35], s42 offen lds
    s_add_u32 m0, s54, 6144
    s_add_u32 s42, s57, 46080
    buffer_load_dwordx4 v16, s[32:35], s42 offen lds
    s_add_u32 m0, s54, 7168
    s_add_u32 s42, s57, 66560
    buffer_load_dwordx4 v17, s[32:35], s42 offen lds
    s_add_u32 m0, s54, 8192
    s_add_u32 s42, s57, 81920
    buffer_load_dwordx4 v16, s[32:35], s42 offen lds
    s_add_u32 m0, s54, 9216
    s_add_u32 s42, s57, 102400
    buffer_load_dwordx4 v17, s[32:35], s42 offen lds
    s_add_u32 m0, s54, 10240
    s_add_u32 s42, s57, 87040
    buffer_load_dwordx4 v16, s[32:35], s42 offen lds
    s_add_u32 m0, s54, 11264
    s_add_u32 s42, s57, 107520
    buffer_load_dwordx4 v17, s[32:35], s42 offen lds
    s_add_u32 m0, s54, 12288
    s_add_u32 s42, s57, 122880
    buffer_load_dwordx4 v16, s[32:35], s42 offen lds
    s_add_u32 m0, s54, 13312
    s_add_u32 s42, s57, 143360
    buffer_load_dwordx4 v17, s[32:35], s42 offen lds
    s_add_u32 m0, s54, 14336
    s_add_u32 s42, s57, 128000
    buffer_load_dwordx4 v16, s[32:35], s42 offen lds
    s_add_u32 m0, s54, 15360
    s_add_u32 s42, s57, 148480
    buffer_load_dwordx4 v17, s[32:35], s42 offen lds
    s_cmp_ge_u32 s69, 10
    s_cbranch_scc1 L_w1
    s_cmp_eq_u32 s67, 15
    s_cbranch_scc1 L_issued
    s_mul_i32 s57, s56, 245760
    s_lshl_b32 s42, s67, 8
    s_add_u32 s57, s57, s42
    s_add_u32 m0, s54, 16384
    s_add_u32 s42, s57, 0
    buffer_load_dwordx4 v18, s[36:39], s42 offen lds
    s_add_u32 m0, s54, 17408
    s_add_u32 s42, s57, 15360
    buffer_load_dwordx4 v18, s[36:39], s42 offen lds
    s_add_u32 m0, s54, 18432
    s_add_u32 s42, s57, 30720
    buffer_load_dwordx4 v19, s[36:39], s42 offen lds
    s_add_u32 m0, s54, 19456
    s_add_u32 s42, s57, 46080
    buffer_load_dwordx4 v19, s[36:39], s42 offen lds
    s_add_u32 m0, s54, 20480
    s_add_u32 s42, s57, 61440
    buffer_load_dwordx4 v18, s[36:39], s42 offen lds
    s_add_u32 m0, s54, 21504
    s_add_u32 s42, s57, 76800
    buffer_load_dwordx4 v18, s[36:39], s42 offen lds
    s_add_u32 m0, s54, 22528
    s_add_u32 s42, s57, 92160
    buffer_load_dwordx4 v19, s[36:39], s42 offen lds
    s_add_u32 m0, s54, 23552
    s_add_u32 s42, s57, 107520
    buffer_load_dwordx4 v19, s[36:39], s42 offen lds
    s_add_u32 m0, s54, 24576
    s_add_u32 s42, s57, 122880
    buffer_load_dwordx4 v18, s[36:39], s42 offen lds
    s_add_u32 m0, s54, 25600
    s_add_u32 s42, s57, 138240
    buffer_load_dwordx4 v18, s[36:39], s42 offen lds
    s_add_u32 m0, s54, 26624
    s_add_u32 s42, s57, 153600
    buffer_load_dwordx4 v19, s[36:39], s42 offen lds
    s_add_u32 m0, s54, 27648
    s_add_u32 s42, s57, 168960
    buffer_load_dwordx4 v19, s[36:39], s42 offen lds
    s_add_u32 m0, s54, 28672
    s_add_u32 s42, s57, 184320
    buffer_load_dwordx4 v18, s[36:39], s42 offen lds
    s_add_u32 m0, s54, 29696
    s_add_u32 s42, s57, 199680
    buffer_load_dwordx4 v18, s[36:39], s42 offen lds
    s_add_u32 m0, s54, 30720
    s_add_u32 s42, s57, 215040
    buffer_load_dwordx4 v19, s[36:39], s42 offen lds
    s_add_u32 m0, s54, 31744
    s_add_u32 s42, s57, 230400
    buffer_load_dwordx4 v19, s[36:39], s42 offen lds
L_issued:
    s_cmp_ge_u32 s69, 4
    s_cbranch_scc1 L_wait
    v_add_u32 v24, 0, v1
    v_mul_u32_u24 v25, 171, v24
    v_lshrrev_b32 v25, 11, v25
    v_mul_u32_u24 v26, 12, v25
    v_sub_u32 v24, v24, v26
    v_lshrrev_b32 v26, 3, v25
    v_lshlrev_b32 v26, 1, v26
    v_xor_b32 v24, v24, v26
    v_mul_u32_u24 v25, 3072, v25
    v_lshl_add_u32 v20, v24, 4, v25
    v_add_u32 v24, 64, v1
    v_mul_u32_u24 v25, 171, v24
    v_lshrrev_b32 v25, 11, v25
    v_mul_u32_u24 v26, 12, v25
    v_sub_u32 v24, v24, v26
    v_lshrrev_b32 v26, 3, v25
    v_lshlrev_b32 v26, 1, v26
    v_xor_b32 v24, v24, v26
    v_mul_u32_u24 v25, 3072, v25
    v_lshl_add_u32 v21, v24, 4, v25
    v_add_u32 v24, 128, v1
    v_mul_u32_u24 v25, 171, v24
    v_lshrrev_b32 v25, 11, v25
    v_mul_u32_u24 v26, 12, v25
    v_sub_u32 v24, v24, v26
    v_lshrrev_b32 v26, 3, v25
    v_lshlrev_b32 v26, 1, v26
    v_xor_b32 v24, v24, v26
    v_mul_u32_u24 v25, 3072, v25
    v_lshl_add_u32 v22, v24, 4, v25
    s_branch L_wait
L_w1:
    s_setprio 2
    s_mul_i32 s57, s56, 196608
    s_mul_i32 s42, s67, 192
    s_add_u32 s57, s57, s42
    s_add_u32 m0, s54, 16384
    s_add_u32 s42, s57, 0
    buffer_load_dwordx4 v20, s[28:31], s42 offen lds
    s_add_u32 m0, s54, 17408
    s_add_u32 s42, s57, 0
    buffer_load_dwordx4 v21, s[28:31], s42 offen lds
    s_add_u32 m0, s54, 18432
    s_add_u32 s42, s57, 0
    buffer_load_dwordx4 v22, s[28:31], s42 offen lds
    s_add_u32 m0, s54, 19456
    s_add_u32 s42, s57, 49152
    buffer_load_dwordx4 v20, s[28:31], s42 offen lds
    s_add_u32 m0, s54, 20480
    s_add_u32 s42, s57, 49152
    buffer_load_dwordx4 v21, s[28:31], s42 offen lds
    s_add_u32 m0, s54, 21504
    s_add_u32 s42, s57, 49152
    buffer_load_dwordx4 v22, s[28:31], s42 offen lds
    s_add_u32 m0, s54, 22528
    s_add_u32 s42, s57, 98304
    buffer_load_dwordx4 v20, s[28:31], s42 offen lds
    s_add_u32 m0, s54, 23552
    s_add_u32 s42, s57, 98304
    buffer_load_dwordx4 v21, s[28:31], s42 offen lds
    s_add_u32 m0, s54, 24576
    s_add_u32 s42, s57, 98304
    buffer_load_dwordx4 v22, s[28:31], s42 offen lds
    s_add_u32 m0, s54, 25600
    s_add_u32 s42, s57, 147456
    buffer_load_dwordx4 v20, s[28:31], s42 offen lds
    s_add_u32 m0, s54, 26624
    s_add_u32 s42, s57, 147456
    buffer_load_dwordx4 v21, s[28:31], s42 offen lds
    s_add_u32 m0, s54, 27648
    s_add_u32 s42, s57, 147456
    buffer_load_dwordx4 v22, s[28:31], s42 offen lds
L_wait:
    s_add_u32 s69, s69, 4
    s_waitcnt vmcnt(0)
    s_mov_b64 exec, 1
    ds_write_b32 v14, v15 offset:32
    s_mov_b64 exec, -1
    v_add_u32 v14, 16, v14
    s_cmp_lt_u32 s69, 20
    s_cbranch_scc1 L_next
    s_mov_b32 s24, s22
    s_mov_b32 s25, s23
    s_mov_b32 s26, 268435456
    s_mov_b32 s27, 0x00020000
    s_and_b32 s42, s2, 7
    s_lshr_b32 s43, s2, 3
    s_lshr_b32 s52, s42, 1
    s_lshl_b32 s52, s52, 4
    s_lshr_b32 s44, s43, 1
    s_add_u32 s52, s52, s44
    s_and_b32 s53, s42, 1
    s_lshl_b32 s53, s53, 1
    s_and_b32 s44, s43, 1
    s_add_u32 s53, s53, s44
    s_lshl_b32 s48, s42, 2
    s_lshr_b32 s44, s2, 6
    s_add_u32 s48, s48, s44
    s_mul_i32 s51, s48, 163840
    s_add_u32 s51, s51, 3145728
    v_lshlrev_b32 v2, 4, v1
    s_mul_i32 s42, s48, 20
    s_add_u32 s43, s42, 19
    s_lshr_b32 s42, s42, 7
    s_lshr_b32 s43, s43, 7
    s_sub_u32 s43, s43, s42
    v_bfe_u32 v96, v1, 3, 1
    v_mad_u32_u24 v96, v96, 5, 5
    v_and_b32 v97, 3, v1
    s_mul_i32 s44, s40, 3
    s_add_u32 s44, s44, 3
    v_add_u32 v97, s44, v97
    v_bfe_u32 v98, v1, 2, 1
    v_and_b32 v98, s43, v98
    v_add3_u32 v96, v96, v98, s42
    v_lshl_add_u32 v96, v96, 4, v97
    v_lshlrev_b32 v96, 7, v96
    s_mov_b32 s44, 22544384
    s_mov_b32 s46, 0x10000
    s_mov_b64 exec, 0xffff
L_kf:
    buffer_load_dword v97, v96, s[24:27], s44 offen sc1
    s_waitcnt vmcnt(0)
    v_cmp_ne_u32 vcc, 0x1010101, v97
    s_cmp_eq_u64 vcc, 0
    s_cbranch_scc1 L_kgo
    s_sleep 8
    s_sub_u32 s46, s46, 1
    s_cmp_lg_u32 s46, 0
    s_cbranch_scc1 L_kf
L_kgo:
    s_mov_b64 exec, -1
    s_mul_i32 s43, s40, 13
    s_add_u32 s43, s43, 12
    s_min_u32 s43, s43, 50
    s_mul_i32 s50, s43, 2560
    s_add_u32 s50, s50, s51
    s_add_u32 s50, s50, 1280
    s_mul_i32 s45, s43, 2576
    v_mov_b32 v96, 2576
    v_mad_u32_u24 v96, v1, v96, s45
    s_add_u32 s45, s45, 16
    s_lshl_b32 s42, s40, 2
    s_lshr_b32 s42, 0xecdd, s42
    s_and_b32 s42, s42, 15
    s_bfm_b64 s[70:71], s42, 0
    v_mov_b32 v104, 0x3f803f80
    v_mov_b32 v105, 0x3f803f80
    v_mov_b32 v106, 0x3f803f80
    v_mov_b32 v107, 0x3f803f80
    s_cmp_eq_u32 s40, 0
    s_cselect_b32 s43, 2, 0
    v_mov_b32 v100, s43
    s_lshl_b32 s43, 4, s40
    s_and_b32 s43, s43, 31
    v_mov_b32 v101, s43
    s_cmp_eq_u32 s40, 3
    s_cselect_b32 s43, 0xc0, 0
    v_mov_b32 v102, s43
    s_lshl_b32 s42, s40, 3
    v_add_u32 v10, s42, v1
    v_and_b32 v10, 31, v10
    v_and_b32 v13, 32, v1
    v_or_b32 v10, v10, v13
    v_lshlrev_b32 v10, 4, v10
    v_add_u32 v3, 0, v10
    v_add_u32 v4, 139264, v10
    v_add_u32 v5, 278528, v10
    v_add_u32 v6, 417792, v10
    v_add_u32 v7, 557056, v10
    s_mul_i32 s44, s40, 24576
    s_mul_i32 s54, s52, 98304
    s_add_u32 s54, s54, s44
    s_add_u32 s54, s54, 9437184
    s_mul_i32 s55, s53, 696320
    s_add_u32 s55, s55, s44
    s_add_u32 s55, s55, 18915328
    v_mov_b32 v16, 0
    v_mov_b32 v17, 0
    v_mov_b32 v18, 0
    v_mov_b32 v19, 0
    v_mov_b32 v20, 0
    v_mov_b32 v21, 0
    v_mov_b32 v22, 0
    v_mov_b32 v23, 0
    v_mov_b32 v24, 0
    v_mov_b32 v25, 0
    v_mov_b32 v26, 0
    v_mov_b32 v27, 0
    v_mov_b32 v28, 0
    v_mov_b32 v29, 0
    v_mov_b32 v30, 0
    v_mov_b32 v31, 0
    v_mov_b32 v32, 0
    v_mov_b32 v33, 0
    v_mov_b32 v34, 0
    v_mov_b32 v35, 0
    v_mov_b32 v36, 0
    v_mov_b32 v37, 0
    v_mov_b32 v38, 0
    v_mov_b32 v39, 0
    v_mov_b32 v40, 0
    v_mov_b32 v41, 0
    v_mov_b32 v42, 0
    v_mov_b32 v43, 0
    v_mov_b32 v44, 0
    v_mov_b32 v45, 0
    v_mov_b32 v46, 0
    v_mov_b32 v47, 0
    v_mov_b32 v48, 0
    v_mov_b32 v49, 0
    v_mov_b32 v50, 0
    v_mov_b32 v51, 0
    v_mov_b32 v52, 0
    v_mov_b32 v53, 0
    v_mov_b32 v54, 0
    v_mov_b32 v55, 0
    v_mov_b32 v56, 0
    v_mov_b32 v57, 0
    v_mov_b32 v58, 0
    v_mov_b32 v59, 0
    v_mov_b32 v60, 0
    v_mov_b32 v61, 0
    v_mov_b32 v62, 0
    v_mov_b32 v63, 0
    v_mov_b32 v64, 0
    v_mov_b32 v65, 0
    v_mov_b32 v66, 0
    v_mov_b32 v67, 0
    v_mov_b32 v68, 0
    v_mov_b32 v69, 0
    v_mov_b32 v70, 0
    v_mov_b32 v71, 0
    v_mov_b32 v72, 0
    v_mov_b32 v73, 0
    v_mov_b32 v74, 0
    v_mov_b32 v75, 0
    v_mov_b32 v76, 0
    v_mov_b32 v77, 0
    v_mov_b32 v78, 0
    v_mov_b32 v79, 0
    v_mov_b32 v80, 0
    v_mov_b32 v81, 0
    v_mov_b32 v82, 0
    v_mov_b32 v83, 0
    v_mov_b32 v84, 0
    v_mov_b32 v85, 0
    v_mov_b32 v86, 0
    v_mov_b32 v87, 0
    v_mov_b32 v88, 0
    v_mov_b32 v89, 0
    v_mov_b32 v90, 0
    v_mov_b32 v91, 0
    v_mov_b32 v92, 0
    v_mov_b32 v93, 0
    v_mov_b32 v94, 0
    v_mov_b32 v95, 0
    s_mov_b32 s46, 0x40000
L_poll2:
    ds_read_b32 v10, v14 offset:96
    s_waitcnt lgkmcnt(0)
    v_readfirstlane_b32 s42, v10
    s_cmp_eq_u32 s42, 4
    s_cbranch_scc1 L_got2
    s_sleep 1
    s_sub_u32 s46, s46, 1
    s_cmp_lg_u32 s46, 0
    s_cbranch_scc1 L_poll2
L_got2:
    v_mov_b32 v14, 163584
    s_cmp_lt_u32 s40, 2
    s_cbranch_scc1 L_fill
    s_mov_b32 s46, 0x40000
L_poll3:
    ds_read_b32 v10, v14 offset:200
    s_waitcnt lgkmcnt(0)
    v_readfirstlane_b32 s42, v10
    s_cmp_eq_u32 s42, 4
    s_cbranch_scc1 L_got3
    s_sleep 2
    s_sub_u32 s46, s46, 1
    s_cmp_lg_u32 s46, 0
    s_cbranch_scc1 L_poll3
L_got3:
L_fill:
    s_add_u32 m0, s45, 0
    s_add_u32 s42, s50, 0
    s_nop 0
    buffer_load_dwordx4 v2, s[24:27], s42 offen sc1 lds
    buffer_load_dwordx4 v2, s[24:27], s42 offen offset:1024 sc1 lds
    s_mov_b32 exec_hi, 0
    buffer_load_dwordx4 v2, s[24:27], s42 offen offset:2048 sc1 lds
    s_mov_b64 exec, -1
    s_mov_b64 exec, s[70:71]
    ds_write_b128 v96, v[104:107]
    s_mov_b64 exec, -1
    s_add_u32 m0, s45, 2576
    s_add_u32 s42, s50, 2560
    buffer_load_dwordx4 v2, s[24:27], s42 offen sc1 lds
    buffer_load_dwordx4 v2, s[24:27], s42 offen offset:1024 sc1 lds
    s_mov_b32 exec_hi, 0
    buffer_load_dwordx4 v2, s[24:27], s42 offen offset:2048 sc1 lds
    s_mov_b64 exec, -1
    s_add_u32 m0, s45, 5152
    s_add_u32 s42, s50, 5120
    buffer_load_dwordx4 v2, s[24:27], s42 offen sc1 lds
    buffer_load_dwordx4 v2, s[24:27], s42 offen offset:1024 sc1 lds
    s_mov_b32 exec_hi, 0
    buffer_load_dwordx4 v2, s[24:27], s42 offen offset:2048 sc1 lds
    s_mov_b64 exec, -1
    s_add_u32 m0, s45, 7728
    s_add_u32 s42, s50, 7680
    buffer_load_dwordx4 v2, s[24:27], s42 offen sc1 lds
    buffer_load_dwordx4 v2, s[24:27], s42 offen offset:1024 sc1 lds
    s_mov_b32 exec_hi, 0
    buffer_load_dwordx4 v2, s[24:27], s42 offen offset:2048 sc1 lds
    s_mov_b64 exec, -1
    s_add_u32 m0, s45, 10304
    s_add_u32 s42, s50, 10240
    buffer_load_dwordx4 v2, s[24:27], s42 offen sc1 lds
    buffer_load_dwordx4 v2, s[24:27], s42 offen offset:1024 sc1 lds
    s_mov_b32 exec_hi, 0
    buffer_load_dwordx4 v2, s[24:27], s42 offen offset:2048 sc1 lds
    s_mov_b64 exec, -1
    s_add_u32 m0, s45, 12880
    s_add_u32 s42, s50, 12800
    buffer_load_dwordx4 v2, s[24:27], s42 offen sc1 lds
    buffer_load_dwordx4 v2, s[24:27], s42 offen offset:1024 sc1 lds
    s_mov_b32 exec_hi, 0
    buffer_load_dwordx4 v2, s[24:27], s42 offen offset:2048 sc1 lds
    s_mov_b64 exec, -1
    s_add_u32 m0, s45, 15456
    s_add_u32 s42, s50, 15360
    buffer_load_dwordx4 v2, s[24:27], s42 offen sc1 lds
    buffer_load_dwordx4 v2, s[24:27], s42 offen offset:1024 sc1 lds
    s_mov_b32 exec_hi, 0
    buffer_load_dwordx4 v2, s[24:27], s42 offen offset:2048 sc1 lds
    s_mov_b64 exec, -1
    s_add_u32 m0, s45, 18032
    s_add_u32 s42, s50, 17920
    buffer_load_dwordx4 v2, s[24:27], s42 offen sc1 lds
    buffer_load_dwordx4 v2, s[24:27], s42 offen offset:1024 sc1 lds
    s_mov_b32 exec_hi, 0
    buffer_load_dwordx4 v2, s[24:27], s42 offen offset:2048 sc1 lds
    s_mov_b64 exec, -1
    s_add_u32 m0, s45, 20608
    s_add_u32 s42, s50, 20480
    buffer_load_dwordx4 v2, s[24:27], s42 offen sc1 lds
    buffer_load_dwordx4 v2, s[24:27], s42 offen offset:1024 sc1 lds
    s_mov_b32 exec_hi, 0
    buffer_load_dwordx4 v2, s[24:27], s42 offen offset:2048 sc1 lds
    s_mov_b64 exec, -1
    s_add_u32 m0, s45, 23184
    s_add_u32 s42, s50, 23040
    buffer_load_dwordx4 v2, s[24:27], s42 offen sc1 lds
    buffer_load_dwordx4 v2, s[24:27], s42 offen offset:1024 sc1 lds
    s_mov_b32 exec_hi, 0
    buffer_load_dwordx4 v2, s[24:27], s42 offen offset:2048 sc1 lds
    s_mov_b64 exec, -1
    s_add_u32 m0, s45, 25760
    s_add_u32 s42, s50, 25600
    buffer_load_dwordx4 v2, s[24:27], s42 offen sc1 lds
    buffer_load_dwordx4 v2, s[24:27], s42 offen offset:1024 sc1 lds
    s_mov_b32 exec_hi, 0
    buffer_load_dwordx4 v2, s[24:27], s42 offen offset:2048 sc1 lds
    s_mov_b64 exec, -1
    s_add_u32 m0, s45, 28336
    s_add_u32 s42, s50, 28160
    buffer_load_dwordx4 v2, s[24:27], s42 offen sc1 lds
    buffer_load_dwordx4 v2, s[24:27], s42 offen offset:1024 sc1 lds
    s_mov_b32 exec_hi, 0
    buffer_load_dwordx4 v2, s[24:27], s42 offen offset:2048 sc1 lds
    s_mov_b64 exec, -1
    s_cmp_eq_u32 s40, 2
    s_cbranch_scc1 L_filled
    s_add_u32 m0, s45, 30912
    s_add_u32 s42, s50, 30720
    buffer_load_dwordx4 v2, s[24:27], s42 offen sc1 lds
    buffer_load_dwordx4 v2, s[24:27], s42 offen offset:1024 sc1 lds
    s_mov_b32 exec_hi, 0
    buffer_load_dwordx4 v2, s[24:27], s42 offen offset:2048 sc1 lds
    s_mov_b64 exec, -1
    s_cmp_lg_u32 s40, 3
    s_cbranch_scc1 L_filled
    s_add_u32 m0, s45, 33488
    s_add_u32 s42, s50, 33280
    buffer_load_dwordx4 v2, s[24:27], s42 offen sc1 lds
    s_mov_b64 exec, 0xffff
    buffer_load_dwordx4 v2, s[24:27], s42 offen offset:1024 sc1 lds
    s_mov_b64 exec, -1
L_filled:
    s_lshl_b32 s44, s40, 11
    s_add_u32 s44, s44, 10240
    v_lshl_add_u32 v112, v1, 7, s44
    v_lshlrev_b32 v10, 4, v1
    v_add_u32 v10, 768, v10
    v_cmp_gt_u32 vcc, 16, v1
    s_nop 1
    v_cndmask_b32 v112, v10, v112, vcc
    v_and_b32 v13, 31, v1
    v_lshlrev_b32 v13, 2, v13
    s_lshl_b32 s45, s52, 7
    s_add_u32 s45, s45, 22020096
    v_and_b32 v11, 3, v1
    v_lshlrev_b32 v11, 7, v11
    s_and_b32 s43, s52, 60
    s_add_u32 s43, s43, s40
    s_lshl_b32 s43, s43, 9
    s_add_u32 s43, s43, 22577152
    s_bfe_u32 s44, s52, 0x10001
    s_lshl_b32 s44, s44, 3
    s_lshl_b32 s44, 0x10001, s44
    s_waitcnt vmcnt(24)
    s_mov_b64 exec, 1
    ds_or_b32 v14, v100 offset:4
    s_mov_b64 exec, -1
    s_waitcnt vmcnt(0)
    s_mov_b64 exec, 1
    ds_or_b32 v14, v101 offset:4
    s_mov_b64 exec, -1
    s_sleep 16
    s_mov_b32 s50, 22609920
    s_mov_b32 s46, 0x10000
    s_mov_b64 exec, 0xfffff
L_if:
    buffer_load_dwordx4 v[108:111], v112, s[24:27], s50 offen sc1
    s_waitcnt vmcnt(0)
    v_and_b32 v108, v108, v109
    v_and_b32 v110, v110, v111
    v_and_b32 v108, v108, v110
    v_cmp_ne_u32 vcc, 0x1010101, v108
    s_cmp_eq_u64 vcc, 0
    s_cbranch_scc1 L_igo
    s_mov_b64 exec, vcc
    s_sleep 16
    s_sub_u32 s46, s46, 1
    s_cmp_lg_u32 s46, 0
    s_cbranch_scc1 L_if
L_igo:
    s_mov_b64 exec, 1
    ds_add_u32 v14, v15 offset:208
    s_mov_b64 exec, -1
    s_mov_b32 s46, 0x40000
L_poll4:
    ds_read_b32 v10, v14 offset:208
    s_waitcnt lgkmcnt(0)
    v_readfirstlane_b32 s42, v10
    s_cmp_eq_u32 s42, 4
    s_cbranch_scc1 L_got4
    s_sleep 2
    s_sub_u32 s46, s46, 1
    s_cmp_lg_u32 s46, 0
    s_cbranch_scc1 L_poll4
L_got4:
    s_mov_b64 exec, 1
    ds_or_b32 v14, v102 offset:4
    s_mov_b64 exec, -1
    s_waitcnt lgkmcnt(0)
    buffer_load_dword v12, v11, s[24:27], s43 offen sc1
    buffer_load_dword v8, v13, s[24:27], s45 offen sc1
    buffer_load_dwordx4 v[100:103], v3, s[24:27], s55 offen offset:0 sc1
    buffer_load_dwordx4 v[104:107], v4, s[24:27], s55 offen offset:0 sc1
    buffer_load_dwordx4 v[108:111], v5, s[24:27], s55 offen offset:0 sc1
    buffer_load_dwordx4 v[112:115], v6, s[24:27], s55 offen offset:0 sc1
    buffer_load_dwordx4 v[116:119], v7, s[24:27], s55 offen offset:0 sc1
    buffer_load_dwordx4 v[124:127], v3, s[24:27], s55 offen offset:1024 sc1
    buffer_load_dwordx4 v[128:131], v4, s[24:27], s55 offen offset:1024 sc1
    buffer_load_dwordx4 v[132:135], v5, s[24:27], s55 offen offset:1024 sc1
    buffer_load_dwordx4 v[136:139], v6, s[24:27], s55 offen offset:1024 sc1
    buffer_load_dwordx4 v[140:143], v7, s[24:27], s55 offen offset:1024 sc1
    buffer_load_dwordx4 v[148:151], v3, s[24:27], s55 offen offset:2048 sc1
    buffer_load_dwordx4 v[152:155], v4, s[24:27], s55 offen offset:2048 sc1
    buffer_load_dwordx4 v[156:159], v5, s[24:27], s55 offen offset:2048 sc1
    buffer_load_dwordx4 v[160:163], v6, s[24:27], s55 offen offset:2048 sc1
    buffer_load_dwordx4 v[164:167], v7, s[24:27], s55 offen offset:2048 sc1
    s_mov_b32 s46, 0x10000
    s_waitcnt vmcnt(16)
L_hf:
    v_and_b32 v12, s44, v12
    v_cmp_ne_u32 vcc, s44, v12
    s_cmp_eq_u64 vcc, 0
    s_cbranch_scc1 L_hgo
    s_sleep 12
    buffer_load_dword v12, v11, s[24:27], s43 offen sc1
    s_sub_u32 s46, s46, 1
    s_cmp_lg_u32 s46, 0
    s_waitcnt vmcnt(0)
    s_cbranch_scc1 L_hf
L_hgo:
    buffer_load_dwordx4 v[96:99], v2, s[24:27], s54 offen offset:0 sc1
    buffer_load_dwordx4 v[120:123], v2, s[24:27], s54 offen offset:1024 sc1
    buffer_load_dwordx4 v[144:147], v2, s[24:27], s54 offen offset:2048 sc1
    s_setprio 0
    s_mov_b32 s47, 7
    s_waitcnt vmcnt(0)
L_gloop:
    s_add_u32 s54, s54, 3072
    s_add_u32 s55, s55, 3072
    s_waitcnt vmcnt(12)
    v_mfma_f32_32x32x16_bf16 v[16:31], v[100:103], v[96:99], v[16:31]
    buffer_load_dwordx4 v[100:103], v3, s[24:27], s55 offen offset:0 sc1
    v_mfma_f32_32x32x16_bf16 v[32:47], v[104:107], v[96:99], v[32:47]
    buffer_load_dwordx4 v[104:107], v4, s[24:27], s55 offen offset:0 sc1
    v_mfma_f32_32x32x16_bf16 v[48:63], v[108:111], v[96:99], v[48:63]
    buffer_load_dwordx4 v[108:111], v5, s[24:27], s55 offen offset:0 sc1
    v_mfma_f32_32x32x16_bf16 v[64:79], v[112:115], v[96:99], v[64:79]
    buffer_load_dwordx4 v[112:115], v6, s[24:27], s55 offen offset:0 sc1
    v_mfma_f32_32x32x16_bf16 v[80:95], v[116:119], v[96:99], v[80:95]
    buffer_load_dwordx4 v[116:119], v7, s[24:27], s55 offen offset:0 sc1
    buffer_load_dwordx4 v[96:99], v2, s[24:27], s54 offen offset:0 sc1
    s_waitcnt vmcnt(12)
    v_mfma_f32_32x32x16_bf16 v[16:31], v[124:127], v[120:123], v[16:31]
    buffer_load_dwordx4 v[124:127], v3, s[24:27], s55 offen offset:1024 sc1
    v_mfma_f32_32x32x16_bf16 v[32:47], v[128:131], v[120:123], v[32:47]
    buffer_load_dwordx4 v[128:131], v4, s[24:27], s55 offen offset:1024 sc1
    v_mfma_f32_32x32x16_bf16 v[48:63], v[132:135], v[120:123], v[48:63]
    buffer_load_dwordx4 v[132:135], v5, s[24:27], s55 offen offset:1024 sc1
    v_mfma_f32_32x32x16_bf16 v[64:79], v[136:139], v[120:123], v[64:79]
    buffer_load_dwordx4 v[136:139], v6, s[24:27], s55 offen offset:1024 sc1
    v_mfma_f32_32x32x16_bf16 v[80:95], v[140:143], v[120:123], v[80:95]
    buffer_load_dwordx4 v[140:143], v7, s[24:27], s55 offen offset:1024 sc1
    buffer_load_dwordx4 v[120:123], v2, s[24:27], s54 offen offset:1024 sc1
    s_waitcnt vmcnt(12)
    v_mfma_f32_32x32x16_bf16 v[16:31], v[148:151], v[144:147], v[16:31]
    buffer_load_dwordx4 v[148:151], v3, s[24:27], s55 offen offset:2048 sc1
    v_mfma_f32_32x32x16_bf16 v[32:47], v[152:155], v[144:147], v[32:47]
    buffer_load_dwordx4 v[152:155], v4, s[24:27], s55 offen offset:2048 sc1
    v_mfma_f32_32x32x16_bf16 v[48:63], v[156:159], v[144:147], v[48:63]
    buffer_load_dwordx4 v[156:159], v5, s[24:27], s55 offen offset:2048 sc1
    v_mfma_f32_32x32x16_bf16 v[64:79], v[160:163], v[144:147], v[64:79]
    buffer_load_dwordx4 v[160:163], v6, s[24:27], s55 offen offset:2048 sc1
    v_mfma_f32_32x32x16_bf16 v[80:95], v[164:167], v[144:147], v[80:95]
    buffer_load_dwordx4 v[164:167], v7, s[24:27], s55 offen offset:2048 sc1
    buffer_load_dwordx4 v[144:147], v2, s[24:27], s54 offen offset:2048 sc1
    s_sub_u32 s47, s47, 1
    s_cmp_lg_u32 s47, 0
    s_cbranch_scc1 L_gloop
    s_waitcnt vmcnt(12)
    v_mfma_f32_32x32x16_bf16 v[16:31], v[100:103], v[96:99], v[16:31]
    v_mfma_f32_32x32x16_bf16 v[32:47], v[104:107], v[96:99], v[32:47]
    v_mfma_f32_32x32x16_bf16 v[48:63], v[108:111], v[96:99], v[48:63]
    v_mfma_f32_32x32x16_bf16 v[64:79], v[112:115], v[96:99], v[64:79]
    v_mfma_f32_32x32x16_bf16 v[80:95], v[116:119], v[96:99], v[80:95]
    s_waitcnt vmcnt(6)
    v_mfma_f32_32x32x16_bf16 v[16:31], v[124:127], v[120:123], v[16:31]
    v_mfma_f32_32x32x16_bf16 v[32:47], v[128:131], v[120:123], v[32:47]
    v_mfma_f32_32x32x16_bf16 v[48:63], v[132:135], v[120:123], v[48:63]
    v_mfma_f32_32x32x16_bf16 v[64:79], v[136:139], v[120:123], v[64:79]
    v_mfma_f32_32x32x16_bf16 v[80:95], v[140:143], v[120:123], v[80:95]
    s_waitcnt vmcnt(0)
    v_mfma_f32_32x32x16_bf16 v[16:31], v[148:151], v[144:147], v[16:31]
    v_mfma_f32_32x32x16_bf16 v[32:47], v[152:155], v[144:147], v[32:47]
    v_mfma_f32_32x32x16_bf16 v[48:63], v[156:159], v[144:147], v[48:63]
    v_mfma_f32_32x32x16_bf16 v[64:79], v[160:163], v[144:147], v[64:79]
    v_mfma_f32_32x32x16_bf16 v[80:95], v[164:167], v[144:147], v[80:95]
    s_setprio 3
    s_mul_i32 s42, s53, 696320
    s_lshl_b32 s43, s40, 13
    s_add_u32 s55, s42, s43
    s_add_u32 s55, s55, 18874368
    s_add_u32 s54, s55, 4096
    s_lshl_b32 s44, s40, 11
    s_add_u32 s42, s42, s44
    s_add_u32 s42, s42, 18907136
    buffer_load_dwordx4 v[96:99], v7, s[24:27], s55 offen offset:0 sc1
    buffer_load_dwordx4 v[100:103], v7, s[24:27], s55 offen offset:1024 sc1
    buffer_load_dwordx4 v[104:107], v7, s[24:27], s55 offen offset:2048 sc1
    buffer_load_dwordx4 v[108:111], v7, s[24:27], s55 offen offset:3072 sc1
    buffer_load_dwordx4 v[112:115], v7, s[24:27], s42 offen offset:0 sc1
    buffer_load_dwordx4 v[116:119], v7, s[24:27], s54 offen offset:0 sc1
    buffer_load_dwordx4 v[120:123], v7, s[24:27], s54 offen offset:1024 sc1
    buffer_load_dwordx4 v[124:127], v7, s[24:27], s54 offen offset:2048 sc1
    buffer_load_dwordx4 v[128:131], v7, s[24:27], s54 offen offset:3072 sc1
    buffer_load_dwordx4 v[132:135], v7, s[24:27], s42 offen offset:1024 sc1
    s_mul_i32 s42, s52, 40960
    s_add_u32 s56, s42, s43
    s_add_u32 s56, s56, 15728640
    s_add_u32 s54, s56, 4096
    s_add_u32 s57, s42, s44
    s_add_u32 s57, s57, 15761408
    s_add_u32 s43, s43, 49152
    s_add_u32 s44, s44, 81920
    s_add_u32 s42, s40, 1
    s_and_b32 s42, s42, 3
    s_mul_i32 s42, s42, 12288
    v_add_u32 v4, s42, v2
    s_add_u32 s42, s40, 2
    s_and_b32 s42, s42, 3
    s_mul_i32 s42, s42, 12288
    v_add_u32 v5, s42, v2
    s_add_u32 s42, s40, 3
    s_and_b32 s42, s42, 3
    s_mul_i32 s42, s42, 12288
    v_add_u32 v6, s42, v2
    s_mul_i32 s42, s40, 12288
    v_add_u32 v3, s42, v2
    v_sub_f32 v8, 1.0, v8
    v_mov_b32 v9, v8
    v_add_u32 v136, s43, v2
    v_add_u32 v137, s44, v2
    v_lshlrev_b32 v138, 3, v1
    v_add_u32 v138, s44, v138
    s_mov_b32 s46, 0x40000
L_poll5:
    ds_read_b32 v10, v14 offset:12
    s_waitcnt lgkmcnt(0)
    v_readfirstlane_b32 s42, v10
    s_cmp_eq_u32 s42, 8
    s_cbranch_scc1 L_got5
    s_sleep 8
    s_sub_u32 s46, s46, 1
    s_cmp_lg_u32 s46, 0
    s_cbranch_scc1 L_poll5
L_got5:
    ds_write_b128 v4, v[20:23] offset:0
    ds_write_b128 v5, v[24:27] offset:4096
    ds_write_b128 v6, v[28:31] offset:8192
    ds_write_b128 v4, v[36:39] offset:1024
    ds_write_b128 v5, v[40:43] offset:5120
    ds_write_b128 v6, v[44:47] offset:9216
    ds_write_b128 v4, v[52:55] offset:2048
    ds_write_b128 v5, v[56:59] offset:6144
    ds_write_b128 v6, v[60:63] offset:10240
    ds_write_b128 v4, v[68:71] offset:3072
    ds_write_b128 v5, v[72:75] offset:7168
    ds_write_b128 v6, v[76:79] offset:11264
    s_waitcnt lgkmcnt(0)
    s_mov_b64 exec, 1
    ds_add_u32 v14, v15 offset:16
    s_mov_b64 exec, -1
    v_pk_mul_f32 v[80:81], v[80:81], v[8:9]
    v_pk_mul_f32 v[82:83], v[82:83], v[8:9]
    v_pk_mul_f32 v[84:85], v[84:85], v[8:9]
    v_pk_mul_f32 v[86:87], v[86:87], v[8:9]
    v_pk_mul_f32 v[88:89], v[88:89], v[8:9]
    v_pk_mul_f32 v[90:91], v[90:91], v[8:9]
    v_pk_mul_f32 v[92:93], v[92:93], v[8:9]
    v_pk_mul_f32 v[94:95], v[94:95], v[8:9]
    s_lshl_b32 s42, s40, 1
    s_lshl_b32 s42, 1, s42
    v_mov_b32 v140, s42
    v_lshlrev_b32 v141, 1, v140
    v_and_b32 v139, 31, v1
    v_mul_u32_u24 v139, 1280, v139
    v_lshrrev_b32 v10, 5, v1
    v_lshl_add_u32 v139, v10, 3, v139
    s_mul_i32 s61, s52, 40960
    s_mul_i32 s42, s53, 320
    s_add_u32 s61, s61, s42
    s_lshl_b32 s42, s40, 4
    s_add_u32 s61, s61, s42
    s_mov_b32 s28, s18
    s_mov_b32 s29, s19
    s_mov_b32 s30, 2621440
    s_mov_b32 s31, 0x00020000
    s_mov_b32 s46, 0x40000
L_poll6:
    ds_read_b32 v10, v14 offset:16
    s_waitcnt lgkmcnt(0)
    v_readfirstlane_b32 s42, v10
    s_cmp_eq_u32 s42, 4
    s_cbranch_scc1 L_got6
    s_sleep 4
    s_sub_u32 s46, s46, 1
    s_cmp_lg_u32 s46, 0
    s_cbranch_scc1 L_poll6
L_got6:
    ds_read_b128 v[20:23], v3 offset:0
    ds_read_b128 v[24:27], v3 offset:4096
    ds_read_b128 v[28:31], v3 offset:8192
    ds_read_b128 v[36:39], v3 offset:1024
    ds_read_b128 v[40:43], v3 offset:5120
    ds_read_b128 v[44:47], v3 offset:9216
    ds_read_b128 v[52:55], v3 offset:2048
    ds_read_b128 v[56:59], v3 offset:6144
    ds_read_b128 v[60:63], v3 offset:10240
    ds_read_b128 v[68:71], v3 offset:3072
    ds_read_b128 v[72:75], v3 offset:7168
    ds_read_b128 v[76:79], v3 offset:11264
    s_waitcnt lgkmcnt(9)
    v_pk_add_f32 v[16:17], v[16:17], v[20:21]
    v_pk_add_f32 v[24:25], v[24:25], v[28:29]
    v_pk_add_f32 v[18:19], v[18:19], v[22:23]
    v_pk_add_f32 v[26:27], v[26:27], v[30:31]
    v_pk_add_f32 v[16:17], v[16:17], v[24:25]
    v_pk_add_f32 v[18:19], v[18:19], v[26:27]
    v_pk_mul_f32 v[16:17], v[16:17], v[8:9]
    v_pk_mul_f32 v[18:19], v[18:19], v[8:9]
    s_waitcnt lgkmcnt(6)
    v_pk_add_f32 v[32:33], v[32:33], v[36:37]
    v_pk_add_f32 v[40:41], v[40:41], v[44:45]
    v_pk_add_f32 v[34:35], v[34:35], v[38:39]
    v_pk_add_f32 v[42:43], v[42:43], v[46:47]
    v_pk_add_f32 v[32:33], v[32:33], v[40:41]
    v_pk_add_f32 v[34:35], v[34:35], v[42:43]
    v_pk_mul_f32 v[32:33], v[32:33], v[8:9]
    v_pk_mul_f32 v[34:35], v[34:35], v[8:9]
    s_waitcnt lgkmcnt(3)
    v_pk_add_f32 v[48:49], v[48:49], v[52:53]
    v_pk_add_f32 v[56:57], v[56:57], v[60:61]
    v_pk_add_f32 v[50:51], v[50:51], v[54:55]
    v_pk_add_f32 v[58:59], v[58:59], v[62:63]
    v_pk_add_f32 v[48:49], v[48:49], v[56:57]
    v_pk_add_f32 v[50:51], v[50:51], v[58:59]
    v_pk_mul_f32 v[48:49], v[48:49], v[8:9]
    v_pk_mul_f32 v[50:51], v[50:51], v[8:9]
    s_waitcnt lgkmcnt(0)
    v_pk_add_f32 v[64:65], v[64:65], v[68:69]
    v_pk_add_f32 v[72:73], v[72:73], v[76:77]
    v_pk_add_f32 v[66:67], v[66:67], v[70:71]
    v_pk_add_f32 v[74:75], v[74:75], v[78:79]
    v_pk_add_f32 v[64:65], v[64:65], v[72:73]
    v_pk_add_f32 v[66:67], v[66:67], v[74:75]
    v_pk_mul_f32 v[64:65], v[64:65], v[8:9]
    v_pk_mul_f32 v[66:67], v[66:67], v[8:9]
    ds_write_b128 v3, v[16:19] offset:0
    ds_write_b128 v3, v[32:35] offset:1024
    ds_write_b128 v3, v[48:51] offset:2048
    ds_write_b128 v3, v[64:67] offset:3072
    s_mov_b32 s58, 3
    s_mov_b32 s59, 0
    s_mov_b64 s[70:71], -1
    s_mov_b64 s[72:73], -1
    s_mov_b64 s[74:75], -1
    s_mov_b64 s[76:77], -1
    s_mov_b64 s[78:79], -1
    s_mov_b64 s[80:81], -1
    s_mov_b64 s[82:83], -1
    s_mov_b64 s[84:85], -1
    s_mov_b64 s[86:87], -1
    s_mov_b64 s[88:89], -1
    v_lshlrev_b32 v142, 10, v1
    v_min_u32 v142, 7168, v142
    v_lshrrev_b32 v11, 8, v142
    s_lshl_b32 s43, s52, 2
    s_add_u32 s43, s43, s40
    s_lshl_b32 s43, s43, 5
    s_add_u32 s43, s43, 22611968
    s_mov_b32 s46, 0x10000
L_jf:
    buffer_load_dword v12, v11, s[24:27], s43 offen sc1
    s_waitcnt vmcnt(0)
    v_cmp_ne_u32 vcc, 1, v12
    s_cmp_eq_u64 vcc, 0
    s_cbranch_scc1 L_jgo
    s_sleep 8
    s_sub_u32 s46, s46, 1
    s_cmp_lg_u32 s46, 0
    s_cbranch_scc1 L_jf
L_jgo:
    s_mov_b32 s46, 0x40000
L_poll7:
    ds_read_b32 v10, v14 offset:20
    s_waitcnt lgkmcnt(0)
    v_readfirstlane_b32 s42, v10
    s_cmp_lg_u32 s42, 0
    s_cbranch_scc1 L_got7
    s_sleep 2
    s_sub_u32 s46, s46, 1
    s_cmp_lg_u32 s46, 0
    s_cbranch_scc1 L_poll7
L_got7:
    s_mov_b32 s46, 0x20000
    s_mov_b64 s[62:63], 0xff
L_col:
    s_mov_b64 exec, s[62:63]
    buffer_load_dword v143, v142, s[24:27], s56 offen offset:1020 sc1
    s_bitcmp1_b32 s59, 0
    s_cbranch_scc0 L_cl0
    s_mov_b64 exec, s[70:71]
    buffer_load_dwordx4 v[16:19], v2, s[24:27], s56 offen offset:0 sc1
    s_mov_b64 exec, s[72:73]
    buffer_load_dwordx4 v[20:23], v2, s[24:27], s56 offen offset:1024 sc1
    s_mov_b64 exec, s[74:75]
    buffer_load_dwordx4 v[24:27], v2, s[24:27], s56 offen offset:2048 sc1
    s_mov_b64 exec, s[76:77]
    buffer_load_dwordx4 v[28:31], v2, s[24:27], s56 offen offset:3072 sc1
    s_mov_b64 exec, s[78:79]
    buffer_load_dwordx4 v[32:35], v2, s[24:27], s57 offen offset:0 sc1
L_cl0:
    s_bitcmp1_b32 s59, 1
    s_cbranch_scc0 L_cl1
    s_mov_b64 exec, s[80:81]
    buffer_load_dwordx4 v[36:39], v2, s[24:27], s54 offen offset:0 sc1
    s_mov_b64 exec, s[82:83]
    buffer_load_dwordx4 v[40:43], v2, s[24:27], s54 offen offset:1024 sc1
    s_mov_b64 exec, s[84:85]
    buffer_load_dwordx4 v[44:47], v2, s[24:27], s54 offen offset:2048 sc1
    s_mov_b64 exec, s[86:87]
    buffer_load_dwordx4 v[48:51], v2, s[24:27], s54 offen offset:3072 sc1
    s_mov_b64 exec, s[88:89]
    buffer_load_dwordx4 v[52:55], v2, s[24:27], s57 offen offset:1024 sc1
L_cl1:
    s_waitcnt vmcnt(0)
    s_bitcmp1_b32 s59, 0
    s_cbranch_scc0 L_cc0
    s_mov_b64 exec, s[70:71]
    ds_write_b128 v136, v[16:19] offset:0
    v_max3_u32 v10, v16, v17, v18
    v_max_u32 v10, v10, v19
    v_cmp_eq_u32 s[70:71], -1, v10
    s_mov_b64 exec, s[72:73]
    ds_write_b128 v136, v[20:23] offset:1024
    v_max3_u32 v10, v20, v21, v22
    v_max_u32 v10, v10, v23
    v_cmp_eq_u32 s[72:73], -1, v10
    s_mov_b64 exec, s[74:75]
    ds_write_b128 v136, v[24:27] offset:2048
    v_max3_u32 v10, v24, v25, v26
    v_max_u32 v10, v10, v27
    v_cmp_eq_u32 s[74:75], -1, v10
    s_mov_b64 exec, s[76:77]
    ds_write_b128 v136, v[28:31] offset:3072
    v_max3_u32 v10, v28, v29, v30
    v_max_u32 v10, v10, v31
    v_cmp_eq_u32 s[76:77], -1, v10
    s_mov_b64 exec, s[78:79]
    ds_write_b128 v137, v[32:35] offset:0
    v_max3_u32 v10, v32, v33, v34
    v_max_u32 v10, v10, v35
    v_cmp_eq_u32 s[78:79], -1, v10
    s_or_b64 vcc, s[70:71], s[72:73]
    s_or_b64 vcc, vcc, s[74:75]
    s_or_b64 vcc, vcc, s[76:77]
    s_or_b64 vcc, vcc, s[78:79]
    s_cbranch_scc1 L_cc0
    s_mov_b64 exec, 1
    ds_or_b32 v14, v140 offset:24
    s_bitset0_b32 s58, 0
L_cc0:
    s_bitcmp1_b32 s59, 1
    s_cbranch_scc0 L_cc1
    s_mov_b64 exec, s[80:81]
    ds_write_b128 v136, v[36:39] offset:4096
    v_max3_u32 v10, v36, v37, v38
    v_max_u32 v10, v10, v39
    v_cmp_eq_u32 s[80:81], -1, v10
    s_mov_b64 exec, s[82:83]
    ds_write_b128 v136, v[40:43] offset:5120
    v_max3_u32 v10, v40, v41, v42
    v_max_u32 v10, v10, v43
    v_cmp_eq_u32 s[82:83], -1, v10
    s_mov_b64 exec, s[84:85]
    ds_write_b128 v136, v[44:47] offset:6144
    v_max3_u32 v10, v44, v45, v46
    v_max_u32 v10, v10, v47
    v_cmp_eq_u32 s[84:85], -1, v10
    s_mov_b64 exec, s[86:87]
    ds_write_b128 v136, v[48:51] offset:7168
    v_max3_u32 v10, v48, v49, v50
    v_max_u32 v10, v10, v51
    v_cmp_eq_u32 s[86:87], -1, v10
    s_mov_b64 exec, s[88:89]
    ds_write_b128 v137, v[52:55] offset:1024
    v_max3_u32 v10, v52, v53, v54
    v_max_u32 v10, v10, v55
    v_cmp_eq_u32 s[88:89], -1, v10
    s_or_b64 vcc, s[80:81], s[82:83]
    s_or_b64 vcc, vcc, s[84:85]
    s_or_b64 vcc, vcc, s[86:87]
    s_or_b64 vcc, vcc, s[88:89]
    s_cbranch_scc1 L_cc1
    s_mov_b64 exec, 1
    ds_or_b32 v14, v141 offset:24
    s_bitset0_b32 s58, 1
L_cc1:
    s_mov_b64 exec, 0xff
    v_cmp_eq_u32 vcc, -1, v143
    s_cmp_eq_u32 s58, 0
    s_cbranch_scc1 L_all
    s_and_b32 s42, vcc_lo, 15
    s_bcnt1_i32_b32 s42, s42
    s_cmp_le_u32 s42, 2
    s_cselect_b32 s42, 1, 0
    s_or_b32 s59, s59, s42
    s_and_b32 s42, vcc_lo, 240
    s_bcnt1_i32_b32 s42, s42
    s_cmp_le_u32 s42, 2
    s_cselect_b32 s42, 2, 0
    s_or_b32 s59, s59, s42
    s_mov_b64 s[62:63], vcc
    s_bitcmp1_b32 s59, 0
    s_cselect_b32 s42, 15, 0
    s_andn2_b32 s62, s62, s42
    s_bitcmp1_b32 s59, 1
    s_cselect_b32 s42, 240, 0
    s_andn2_b32 s62, s62, s42
    s_and_b32 s59, s59, s58
    s_cbranch_scc1 L_cn
    s_sleep 6
L_cn:
    s_sleep 2
    s_sub_u32 s46, s46, 1
    s_cmp_lg_u32 s46, 0
    s_cbranch_scc1 L_col
L_all:
    s_mov_b64 exec, -1
    ds_read2st64_b64 v[56:59], v138 offset0:0 offset1:1
    ds_read2st64_b64 v[60:63], v138 offset0:2 offset1:3
    v_mfma_f32_32x32x16_bf16 v[80:95], v[96:99], v[16:19], v[80:95]
    v_mfma_f32_32x32x16_bf16 v[80:95], v[100:103], v[20:23], v[80:95]
    v_mfma_f32_32x32x16_bf16 v[80:95], v[104:107], v[24:27], v[80:95]
    v_mfma_f32_32x32x16_bf16 v[80:95], v[108:111], v[28:31], v[80:95]
    v_mfma_f32_32x32x16_bf16 v[80:95], v[116:119], v[36:39], v[80:95]
    v_mfma_f32_32x32x16_bf16 v[80:95], v[120:123], v[40:43], v[80:95]
    v_mfma_f32_32x32x16_bf16 v[80:95], v[124:127], v[44:47], v[80:95]
    v_mfma_f32_32x32x16_bf16 v[80:95], v[128:131], v[48:51], v[80:95]
    s_waitcnt lgkmcnt(0)
    v_mfma_f32_32x32x16_bf16 v[80:95], v[112:115], v[56:59], v[80:95]
    v_mfma_f32_32x32x16_bf16 v[80:95], v[132:135], v[60:63], v[80:95]
    s_nop 11
    ds_write_b128 v3, v[84:87] offset:8192
    ds_write_b128 v3, v[88:91] offset:9216
    ds_write_b128 v3, v[92:95] offset:10240
    s_waitcnt lgkmcnt(0)
    s_barrier
    ds_read_b128 v[84:87], v6 offset:8192
    ds_read_b128 v[88:91], v5 offset:9216
    ds_read_b128 v[92:95], v4 offset:10240
    s_waitcnt lgkmcnt(0)
    v_pk_add_f32 v[80:81], v[80:81], v[84:85]
    v_pk_add_f32 v[88:89], v[88:89], v[92:93]
    v_pk_add_f32 v[82:83], v[82:83], v[86:87]
    v_pk_add_f32 v[90:91], v[90:91], v[94:95]
    v_pk_add_f32 v[80:81], v[80:81], v[88:89]
    v_pk_add_f32 v[82:83], v[82:83], v[90:91]
    v_cvt_pk_bf16_f32 v80, v80, v81
    v_cvt_pk_bf16_f32 v81, v82, v83
    buffer_store_dwordx2 v[80:81], v139, s[28:31], s61 offen offset:256
    s_endpgm
L_compute:
    s_sub_u32 s41, s40, 4
    s_and_b32 s80, s40, 1
    s_bfe_u32 s81, s40, 0x10001
    v_mov_b32 v164, 163584
    v_mov_b32 v165, 1
    s_waitcnt lgkmcnt(0)
    s_mov_b32 s24, s22
    s_mov_b32 s25, s23
    s_mov_b32 s26, 268435456
    s_mov_b32 s27, 0x00020000
    s_cmp_ge_u32 s40, 8
    s_cbranch_scc1 L_setup
    s_lshl_b32 s70, s41, 8
    s_add_u32 s70, s70, s2
    s_sub_u32 s42, s70, 768
    s_cmp_ge_u32 s42, 16
    s_cbranch_scc1 L_norst
    s_lshl_b32 s42, s2, 12
    s_lshl_b32 s43, s2, 9
    s_add_u32 s43, s43, 75776
    s_lshl_b32 s44, s2, 2
    v_lshl_add_u32 v72, v1, 7, s42
    v_bfe_u32 v74, v1, 2, 2
    v_lshl_add_u32 v73, v74, 7, s43
    v_and_b32 v74, 3, v1
    v_lshl_add_u32 v73, v74, 2, v73
    v_cmp_gt_u32 vcc, 32, v1
    s_nop 1
    v_cndmask_b32 v72, v73, v72, vcc
    s_add_u32 s43, s44, 66560
    v_writelane_b32 v72, s43, 48
    v_mov_b32 v73, 0
    v_mov_b32 v74, s44
    s_mov_b32 s42, 22544384
    s_mov_b32 exec_hi, 0x1ffff
    buffer_store_dword v73, v72, s[24:27], s42 offen sc1
    s_mov_b32 exec_hi, -1
    v_mov_b32 v76, 0
    v_mov_b32 v77, 0
    v_lshlrev_b32 v75, 3, v1
    s_lshl_b32 s42, s2, 9
    s_add_u32 s42, s42, 22611968
    buffer_store_dwordx2 v[76:77], v75, s[24:27], s42 offen sc1
    s_mov_b64 exec, 1
    s_waitcnt vmcnt(0)
    global_store_dword v74, v165, s[20:21] sc1
    s_mov_b64 exec, -1
L_norst:
    s_mul_i32 s71, s70, 6554
    s_lshr_b32 s71, s71, 16
    s_mul_i32 s73, s71, 10
    s_sub_u32 s72, s70, s73
    s_mul_i32 s73, s71, 20
    s_sub_u32 s74, s71, 32
    s_mul_i32 s74, s74, 80
    s_add_u32 s74, s74, 16
    s_cmp_lt_u32 s71, 32
    s_cselect_b32 s73, s73, s74
    s_mov_b32 s75, 51200
    s_cmov_b32 s75, 5120
    s_mov_b32 s76, 25600
    s_cmov_b32 s76, 10240
    s_sub_u32 s74, s71, 40
    s_lshl_b32 s74, s74, 4
    s_cmp_lt_u32 s71, 40
    s_cselect_b32 s73, s73, s74
    s_cselect_b32 s75, s75, 10240
    s_cselect_b32 s76, s76, 5120
    s_cselect_b32 s32, s8, s14
    s_cselect_b32 s33, s9, s15
    s_mov_b32 s34, 1966080
    s_cmov_b32 s34, 819200
    s_mov_b32 s35, 0x00020000
    s_mul_i32 s73, s73, 1280
    s_lshl_b32 s74, s72, 7
    s_add_u32 s73, s73, s74
    s_add_u32 s74, s73, s75
    v_lshrrev_b32 v68, 5, v1
    v_bfe_u32 v69, v1, 3, 2
    v_mul_u32_u24 v69, 1280, v69
    v_mad_u32_u24 v68, v68, s76, v69
    v_and_b32 v69, 7, v1
    v_lshl_add_u32 v68, v69, 4, v68
    s_lshl_b32 s75, s41, 12
    s_add_u32 m0, s75, 0
    s_nop 0
    buffer_load_dwordx4 v68, s[32:35], s73 offen lds
    s_add_u32 m0, s75, 1024
    s_nop 0
    buffer_load_dwordx4 v68, s[32:35], s74 offen lds
    s_add_u32 s70, s70, 1024
    s_cmp_ge_u32 s70, 1360
    s_cbranch_scc1 L_one
    s_mul_i32 s71, s70, 6554
    s_lshr_b32 s71, s71, 16
    s_mul_i32 s73, s71, 10
    s_sub_u32 s72, s70, s73
    s_mul_i32 s73, s71, 20
    s_sub_u32 s74, s71, 32
    s_mul_i32 s74, s74, 80
    s_add_u32 s74, s74, 16
    s_cmp_lt_u32 s71, 32
    s_cselect_b32 s73, s73, s74
    s_mov_b32 s75, 51200
    s_cmov_b32 s75, 5120
    s_mov_b32 s76, 25600
    s_cmov_b32 s76, 10240
    s_sub_u32 s74, s71, 40
    s_lshl_b32 s74, s74, 4
    s_cmp_lt_u32 s71, 40
    s_cselect_b32 s73, s73, s74
    s_cselect_b32 s75, s75, 10240
    s_cselect_b32 s76, s76, 5120
    s_cselect_b32 s32, s8, s14
    s_cselect_b32 s33, s9, s15
    s_mov_b32 s34, 1966080
    s_cmov_b32 s34, 819200
    s_mov_b32 s35, 0x00020000
    s_mul_i32 s73, s73, 1280
    s_lshl_b32 s74, s72, 7
    s_add_u32 s73, s73, s74
    s_add_u32 s74, s73, s75
    v_lshrrev_b32 v70, 5, v1
    v_bfe_u32 v71, v1, 3, 2
    v_mul_u32_u24 v71, 1280, v71
    v_mad_u32_u24 v70, v70, s76, v71
    v_and_b32 v71, 7, v1
    v_lshl_add_u32 v70, v71, 4, v70
    s_lshl_b32 s75, s41, 12
    s_add_u32 m0, s75, 2048
    s_nop 0
    buffer_load_dwordx4 v70, s[32:35], s73 offen lds
    s_add_u32 m0, s75, 3072
    s_nop 0
    buffer_load_dwordx4 v70, s[32:35], s74 offen lds
L_one:
L_setup:
    v_and_b32 v6, 31, v1
    v_lshrrev_b32 v7, 5, v1
    v_lshlrev_b32 v2, 4, v1
    v_and_b32 v3, 24, v6
    v_lshlrev_b32 v3, 3, v3
    v_and_b32 v8, 3, v6
    v_lshl_add_u32 v3, v8, 4, v3
    v_and_b32 v8, 4, v6
    v_lshl_add_u32 v3, v8, 1, v3
    v_lshl_add_u32 v3, v7, 2, v3
    v_add_u32 v3, 1024, v3
    v_bfe_u32 v8, v6, 2, 2
    v_xor_b32 v8, v8, v7
    v_lshlrev_b32 v8, 4, v8
    v_lshl_add_u32 v8, v6, 6, v8
    v_xor_b32 v9, 32, v8
    v_add_u32 v8, 16, v8
    v_add_u32 v9, 16, v9
    v_cmp_gt_u32 vcc, 20, v6
    s_nop 1
    v_cndmask_b32 v4, 0, v8, vcc
    v_cndmask_b32 v5, 0, v9, vcc
    s_and_b32 s42, s2, 7
    s_lshr_b32 s43, s2, 3
    s_lshr_b32 s52, s42, 1
    s_lshl_b32 s52, s52, 4
    s_lshr_b32 s44, s43, 1
    s_add_u32 s52, s52, s44
    s_and_b32 s53, s42, 1
    s_lshl_b32 s53, s53, 1
    s_and_b32 s44, s43, 1
    s_add_u32 s53, s53, s44
    s_lshl_b32 s48, s42, 2
    s_lshr_b32 s44, s2, 6
    s_add_u32 s48, s48, s44
    s_mul_i32 s51, s48, 163840
    s_add_u32 s51, s51, 3145728
    s_bfe_u32 s49, s2, 0x30003
    s_lshl_b32 s49, s49, 3
    s_add_u32 s49, s49, s41
    s_and_b32 s60, s41, 1
    s_lshl_b32 s60, s60, 2
    s_lshr_b32 s43, s41, 1
    s_mul_i32 s42, s53, 5
    s_add_u32 s42, s42, s43
    s_mul_i32 s42, s42, 139264
    s_lshl_b32 s44, s60, 12
    s_add_u32 s55, s42, s44
    s_add_u32 s55, s55, 18874368
    s_lshl_b32 s44, s60, 10
    s_add_u32 s54, s42, s44
    s_add_u32 s54, s54, 18907136
    s_lshl_b32 s44, s60, 2
    v_xor_b32 v166, s44, v1
    v_lshlrev_b32 v166, 4, v166
    s_mul_i32 s61, s52, 40960
    s_mul_i32 s42, s53, 320
    s_add_u32 s61, s61, s42
    s_lshl_b32 s42, s41, 5
    s_add_u32 s61, s61, s42
    s_mul_i32 s42, s49, 40960
    s_lshl_b32 s43, s48, 10
    s_add_u32 s56, s42, s43
    s_add_u32 s56, s56, 15728640
    s_lshr_b32 s43, s48, 2
    s_lshl_b32 s43, s43, 10
    s_add_u32 s57, s42, s43
    s_and_b32 s43, s48, 1
    s_lshl_b32 s43, s43, 9
    s_add_u32 s57, s57, s43
    s_bfe_u32 s43, s48, 0x10001
    s_lshl_b32 s43, s43, 8
    s_add_u32 s57, s57, s43
    s_add_u32 s57, s57, 15761408
    s_mov_b64 s[62:63], -1
    s_xor_b32 s42, s52, s41
    s_bitcmp0_b32 s42, 2
    s_cselect_b64 s[64:65], 1, 0
    s_mov_b32 s28, s18
    s_mov_b32 s29, s19
    s_mov_b32 s30, 2621440
    s_mov_b32 s31, 0x00020000
    s_lshl_b32 s94, s48, 6
    s_add_u32 s94, s94, s49
    s_mul_i32 s94, s94, 1280
    s_lshl_b32 s42, s49, 5
    s_add_u32 s42, s42, s48
    s_lshl_b32 s42, s42, 2
    s_add_u32 s42, s42, 22611968
    v_mov_b32 v19, s42
    s_lshl_b32 s43, s66, 4
    s_add_u32 s43, s43, s67
    s_lshl_b32 s43, s43, 7
    s_add_u32 s43, s43, s41
    s_add_u32 s43, s43, 22577152
    s_lshr_b32 s42, s2, 2
    s_mul_i32 s42, s42, 112
    s_lshl2_add_u32 s42, s2, s42
    s_add_u32 s42, s42, 22620160
    s_cmp_lt_u32 s41, 4
    s_cselect_b32 s43, s43, s42
    s_mov_b64 s[96:97], 2
    v_writelane_b32 v19, s43, 1
    s_cmp_lt_u32 s40, 8
    s_cbranch_scc1 L_late
    s_setprio 3
    v_and_b32 v36, 15, v1
    v_lshrrev_b32 v37, 4, v1
    v_bfe_u32 v38, v1, 2, 2
    v_and_b32 v39, 3, v1
    v_lshrrev_b32 v40, 1, v36
    v_xor_b32 v40, v40, v37
    v_lshlrev_b32 v40, 4, v40
    v_lshl_add_u32 v40, v36, 7, v40
    s_lshl_b32 s42, s80, 13
    s_add_u32 s42, s42, 32512
    v_add_u32 v12, s42, v40
    v_xor_b32 v13, 64, v12
    v_lshl_add_u32 v40, v37, 3, v38
    v_and_b32 v41, 1, v37
    s_mov_b32 s68, 0
    v_lshl_or_b32 v42, v41, 2, v38
    s_lshl_b32 s42, s81, 2
    s_add_u32 s43, s42, 0
    v_xor_b32 v14, s43, v42
    v_lshlrev_b32 v14, 5, v14
    v_lshl_add_u32 v14, v40, 8, v14
    v_lshl_add_u32 v14, v39, 3, v14
    v_add_u32 v14, 32512, v14
    s_add_u32 s43, s42, 1
    v_xor_b32 v15, s43, v42
    v_lshlrev_b32 v15, 5, v15
    v_lshl_add_u32 v15, v40, 8, v15
    v_lshl_add_u32 v15, v39, 3, v15
    v_add_u32 v15, 32512, v15
    s_add_u32 s43, s42, 2
    v_xor_b32 v16, s43, v42
    v_lshlrev_b32 v16, 5, v16
    v_lshl_add_u32 v16, v40, 8, v16
    v_lshl_add_u32 v16, v39, 3, v16
    v_add_u32 v16, 32512, v16
    s_add_u32 s43, s42, 3
    v_xor_b32 v17, s43, v42
    v_lshlrev_b32 v17, 5, v17
    v_lshl_add_u32 v17, v40, 8, v17
    v_lshl_add_u32 v17, v39, 3, v17
    v_add_u32 v17, 32512, v17
    v_mov_b32 v100, 0
    v_mov_b32 v101, 0
    v_mov_b32 v102, 0
    v_mov_b32 v103, 0
    v_mov_b32 v104, 0
    v_mov_b32 v105, 0
    v_mov_b32 v106, 0
    v_mov_b32 v107, 0
    v_mov_b32 v108, 0
    v_mov_b32 v109, 0
    v_mov_b32 v110, 0
    v_mov_b32 v111, 0
    v_mov_b32 v112, 0
    v_mov_b32 v113, 0
    v_mov_b32 v114, 0
    v_mov_b32 v115, 0
    v_mov_b32 v116, 0
    v_mov_b32 v117, 0
    v_mov_b32 v118, 0
    v_mov_b32 v119, 0
    v_mov_b32 v120, 0
    v_mov_b32 v121, 0
    v_mov_b32 v122, 0
    v_mov_b32 v123, 0
    v_mov_b32 v124, 0
    v_mov_b32 v125, 0
    v_mov_b32 v126, 0
    v_mov_b32 v127, 0
    v_mov_b32 v128, 0
    v_mov_b32 v129, 0
    v_mov_b32 v130, 0
    v_mov_b32 v131, 0
    v_mov_b32 v132, 0
    v_mov_b32 v133, 0
    v_mov_b32 v134, 0
    v_mov_b32 v135, 0
    v_mov_b32 v136, 0
    v_mov_b32 v137, 0
    v_mov_b32 v138, 0
    v_mov_b32 v139, 0
    v_mov_b32 v140, 0
    v_mov_b32 v141, 0
    v_mov_b32 v142, 0
    v_mov_b32 v143, 0
    v_mov_b32 v144, 0
    v_mov_b32 v145, 0
    v_mov_b32 v146, 0
    v_mov_b32 v147, 0
    v_mov_b32 v148, 0
    v_mov_b32 v149, 0
    v_mov_b32 v150, 0
    v_mov_b32 v151, 0
    v_mov_b32 v152, 0
    v_mov_b32 v153, 0
    v_mov_b32 v154, 0
    v_mov_b32 v155, 0
    v_mov_b32 v156, 0
    v_mov_b32 v157, 0
    v_mov_b32 v158, 0
    v_mov_b32 v159, 0
    v_mov_b32 v160, 0
    v_mov_b32 v161, 0
    v_mov_b32 v162, 0
    v_mov_b32 v163, 0
    v_and_b32 v40, 12, v36
    v_add_u32 v40, v40, v36
    v_lshl_add_u32 v38, v41, 2, v40
    v_lshrrev_b32 v39, 1, v37
    s_lshl_b32 s82, s66, 2
    s_lshl_b32 s42, s80, 1
    s_add_u32 s82, s82, s42
    s_lshl_b32 s83, s67, 1
    s_add_u32 s83, s83, s81
    s_cmp_ge_u32 s67, 10
    s_cbranch_scc1 L_vg
    s_cmp_lt_u32 s67, 5
    s_cselect_b32 s42, 0x3ea52b5c, 1.0
    s_mov_b32 s44, 163840
    s_cmov_b32 s44, 81920
    s_mov_b32 s45, 2560
    s_cmov_b32 s45, 1280
    s_mov_b32 s70, 3145728
    s_cmov_b32 s70, 0
    s_cselect_b32 s43, 0, 10
    v_mov_b32 v32, s42
    v_mov_b32 v33, s42
    s_sub_u32 s83, s83, s43
    s_lshl_b32 s83, s83, 3
    s_mul_i32 s42, s82, s45
    s_add_u32 s70, s70, s42
    s_add_u32 s71, s70, s45
    v_lshlrev_b32 v38, 4, v38
    v_lshlrev_b32 v36, 4, v36
    v_add_u32 v36, 1024, v36
    s_add_u32 s42, s83, 0
    v_add_u32 v44, s42, v39
    v_mul_u32_u24 v45, 205, v44
    v_lshrrev_b32 v45, 10, v45
    v_mul_u32_u24 v46, 5, v45
    v_sub_u32 v44, v44, v46
    v_cmp_ne_u32 s[72:73], 2, v44
    v_cmp_lt_u32 vcc, 2, v44
    s_nop 1
    v_cndmask_b32 v46, 0, 1, vcc
    v_mul_u32_u24 v47, 3, v46
    v_sub_u32 v44, v44, v47
    v_lshl_add_u32 v44, v44, 9, v38
    v_cndmask_b32 v46, v41, v46, s[72:73]
    v_cndmask_b32 v44, v36, v44, s[72:73]
    v_lshl_add_u32 v45, v45, 1, v46
    v_mad_u32_u24 v28, v45, s44, v44
    s_add_u32 s42, s83, 2
    v_add_u32 v44, s42, v39
    v_mul_u32_u24 v45, 205, v44
    v_lshrrev_b32 v45, 10, v45
    v_mul_u32_u24 v46, 5, v45
    v_sub_u32 v44, v44, v46
    v_cmp_ne_u32 s[74:75], 2, v44
    v_cmp_lt_u32 vcc, 2, v44
    s_nop 1
    v_cndmask_b32 v46, 0, 1, vcc
    v_mul_u32_u24 v47, 3, v46
    v_sub_u32 v44, v44, v47
    v_lshl_add_u32 v44, v44, 9, v38
    v_cndmask_b32 v46, v41, v46, s[74:75]
    v_cndmask_b32 v44, v36, v44, s[74:75]
    v_lshl_add_u32 v45, v45, 1, v46
    v_mad_u32_u24 v29, v45, s44, v44
    s_add_u32 s42, s83, 4
    v_add_u32 v44, s42, v39
    v_mul_u32_u24 v45, 205, v44
    v_lshrrev_b32 v45, 10, v45
    v_mul_u32_u24 v46, 5, v45
    v_sub_u32 v44, v44, v46
    v_cmp_ne_u32 s[76:77], 2, v44
    v_cmp_lt_u32 vcc, 2, v44
    s_nop 1
    v_cndmask_b32 v46, 0, 1, vcc
    v_mul_u32_u24 v47, 3, v46
    v_sub_u32 v44, v44, v47
    v_lshl_add_u32 v44, v44, 9, v38
    v_cndmask_b32 v46, v41, v46, s[76:77]
    v_cndmask_b32 v44, v36, v44, s[76:77]
    v_lshl_add_u32 v45, v45, 1, v46
    v_mad_u32_u24 v30, v45, s44, v44
    s_add_u32 s42, s83, 6
    v_add_u32 v44, s42, v39
    v_mul_u32_u24 v45, 205, v44
    v_lshrrev_b32 v45, 10, v45
    v_mul_u32_u24 v46, 5, v45
    v_sub_u32 v44, v44, v46
    v_cmp_ne_u32 s[78:79], 2, v44
    v_cmp_lt_u32 vcc, 2, v44
    s_nop 1
    v_cndmask_b32 v46, 0, 1, vcc
    v_mul_u32_u24 v47, 3, v46
    v_sub_u32 v44, v44, v47
    v_lshl_add_u32 v44, v44, 9, v38
    v_cndmask_b32 v46, v41, v46, s[78:79]
    v_cndmask_b32 v44, v36, v44, s[78:79]
    v_lshl_add_u32 v45, v45, 1, v46
    v_mad_u32_u24 v31, v45, s44, v44
    s_mov_b32 s47, 9
    s_branch L_qk_first
L_qk_top:
    s_waitcnt lgkmcnt(9)
    v_mfma_f32_16x16x32_bf16 v[100:103], v[52:55], v[36:39], v[100:103]
    ds_read_b64_tr_b16 v[84:85], v14 offset:24576
    ds_read_b64_tr_b16 v[86:87], v14 offset:25600
    s_cmp_eq_u32 s68, 3
    s_mov_b32 s43, 32768
    s_cmov_b32 s43, -98304
    s_add_u32 s68, s68, 1
    s_and_b32 s68, s68, 3
    s_waitcnt lgkmcnt(10)
    v_mfma_f32_16x16x32_bf16 v[104:107], v[52:55], v[40:43], v[104:107]
    ds_read_b128 v[68:71], v13 offset:0
    s_waitcnt lgkmcnt(10)
    v_mfma_f32_16x16x32_bf16 v[108:111], v[52:55], v[44:47], v[108:111]
    ds_read_b128 v[72:75], v13 offset:2048
    s_waitcnt lgkmcnt(10)
    v_mfma_f32_16x16x32_bf16 v[112:115], v[52:55], v[48:51], v[112:115]
    ds_read_b128 v[76:79], v13 offset:4096
    ds_read_b128 v[80:83], v13 offset:6144
    s_waitcnt lgkmcnt(10)
    v_mfma_f32_16x16x32_bf16 v[116:119], v[56:59], v[36:39], v[116:119]
    ds_read_b64_tr_b16 v[88:89], v15 offset:24576
    v_mfma_f32_16x16x32_bf16 v[120:123], v[56:59], v[40:43], v[120:123]
    ds_read_b64_tr_b16 v[90:91], v15 offset:25600
    v_mfma_f32_16x16x32_bf16 v[124:127], v[56:59], v[44:47], v[124:127]
    ds_read_b64_tr_b16 v[92:93], v16 offset:24576
    ds_read_b64_tr_b16 v[94:95], v16 offset:25600
    v_mfma_f32_16x16x32_bf16 v[128:131], v[56:59], v[48:51], v[128:131]
    ds_read_b64_tr_b16 v[96:97], v17 offset:24576
    s_waitcnt lgkmcnt(13)
    v_mfma_f32_16x16x32_bf16 v[132:135], v[60:63], v[36:39], v[132:135]
    ds_read_b32 v167, v164 offset:36
    ds_read_b64_tr_b16 v[98:99], v17 offset:25600
    s_mov_b64 exec, 1
    ds_add_u32 v164, v165 offset:112
    s_mov_b64 exec, -1
    v_mfma_f32_16x16x32_bf16 v[136:139], v[60:63], v[40:43], v[136:139]
    v_add_u32 v12, s43, v12
    v_add_u32 v13, s43, v13
    v_mfma_f32_16x16x32_bf16 v[140:143], v[60:63], v[44:47], v[140:143]
    v_add_u32 v14, s43, v14
    v_mfma_f32_16x16x32_bf16 v[144:147], v[60:63], v[48:51], v[144:147]
    v_add_u32 v15, s43, v15
    s_waitcnt lgkmcnt(14)
    v_mfma_f32_16x16x32_bf16 v[148:151], v[64:67], v[36:39], v[148:151]
    v_add_u32 v16, s43, v16
    v_mfma_f32_16x16x32_bf16 v[152:155], v[64:67], v[40:43], v[152:155]
    v_add_u32 v17, s43, v17
    s_waitcnt lgkmcnt(2)
    v_readfirstlane_b32 s42, v167
    v_mfma_f32_16x16x32_bf16 v[156:159], v[64:67], v[44:47], v[156:159]
    v_add_u32 v164, 4, v164
    s_min_u32 s42, s42, s47
    s_cmp_eq_u32 s42, 0
    v_mfma_f32_16x16x32_bf16 v[160:163], v[64:67], v[48:51], v[160:163]
    s_cbranch_scc1 L_qk_late
    s_sub_u32 s47, s47, 1
    v_mfma_f32_16x16x32_bf16 v[100:103], v[84:87], v[68:71], v[100:103]
    ds_read_b64_tr_b16 v[52:53], v14 offset:16384
    ds_read_b64_tr_b16 v[54:55], v14 offset:17408
    v_mfma_f32_16x16x32_bf16 v[104:107], v[84:87], v[72:75], v[104:107]
    ds_read_b128 v[36:39], v12 offset:0
    v_mfma_f32_16x16x32_bf16 v[108:111], v[84:87], v[76:79], v[108:111]
    ds_read_b128 v[40:43], v12 offset:2048
    v_mfma_f32_16x16x32_bf16 v[112:115], v[84:87], v[80:83], v[112:115]
    ds_read_b128 v[44:47], v12 offset:4096
    ds_read_b128 v[48:51], v12 offset:6144
    v_mfma_f32_16x16x32_bf16 v[116:119], v[88:91], v[68:71], v[116:119]
    ds_read_b64_tr_b16 v[56:57], v15 offset:16384
    v_mfma_f32_16x16x32_bf16 v[120:123], v[88:91], v[72:75], v[120:123]
    ds_read_b64_tr_b16 v[58:59], v15 offset:17408
    v_mfma_f32_16x16x32_bf16 v[124:127], v[88:91], v[76:79], v[124:127]
    ds_read_b64_tr_b16 v[60:61], v16 offset:16384
    ds_read_b64_tr_b16 v[62:63], v16 offset:17408
    v_mfma_f32_16x16x32_bf16 v[128:131], v[88:91], v[80:83], v[128:131]
    ds_read_b64_tr_b16 v[64:65], v17 offset:16384
    v_mfma_f32_16x16x32_bf16 v[132:135], v[92:95], v[68:71], v[132:135]
    ds_read_b64_tr_b16 v[66:67], v17 offset:17408
    v_mfma_f32_16x16x32_bf16 v[136:139], v[92:95], v[72:75], v[136:139]
    v_mfma_f32_16x16x32_bf16 v[140:143], v[92:95], v[76:79], v[140:143]
    v_mfma_f32_16x16x32_bf16 v[144:147], v[92:95], v[80:83], v[144:147]
    s_waitcnt lgkmcnt(13)
    v_mfma_f32_16x16x32_bf16 v[148:151], v[96:99], v[68:71], v[148:151]
    v_mfma_f32_16x16x32_bf16 v[152:155], v[96:99], v[72:75], v[152:155]
    v_mfma_f32_16x16x32_bf16 v[156:159], v[96:99], v[76:79], v[156:159]
    v_mfma_f32_16x16x32_bf16 v[160:163], v[96:99], v[80:83], v[160:163]
    s_branch L_qk_top
L_qk_again:
    s_sub_u32 s47, s47, 1
L_qk_first:
    s_mov_b32 s46, 0x40000
L_poll8:
    ds_read_b32 v167, v164 offset:32
    s_waitcnt lgkmcnt(0)
    v_readfirstlane_b32 s42, v167
    s_cmp_eq_u32 s42, 1
    s_cbranch_scc1 L_got8
    s_sub_u32 s46, s46, 1
    s_cmp_lg_u32 s46, 0
    s_cbranch_scc1 L_poll8
L_got8:
    ds_read_b64_tr_b16 v[52:53], v14 offset:16384
    ds_read_b64_tr_b16 v[54:55], v14 offset:17408
    ds_read_b128 v[36:39], v12 offset:0
    ds_read_b128 v[40:43], v12 offset:2048
    ds_read_b128 v[44:47], v12 offset:4096
    ds_read_b128 v[48:51], v12 offset:6144
    ds_read_b64_tr_b16 v[56:57], v15 offset:16384
    ds_read_b64_tr_b16 v[58:59], v15 offset:17408
    ds_read_b64_tr_b16 v[60:61], v16 offset:16384
    ds_read_b64_tr_b16 v[62:63], v16 offset:17408
    ds_read_b64_tr_b16 v[64:65], v17 offset:16384
    ds_read_b64_tr_b16 v[66:67], v17 offset:17408
    s_branch L_qk_top
L_qk_late:
    v_mfma_f32_16x16x32_bf16 v[100:103], v[84:87], v[68:71], v[100:103]
    v_mfma_f32_16x16x32_bf16 v[104:107], v[84:87], v[72:75], v[104:107]
    v_mfma_f32_16x16x32_bf16 v[108:111], v[84:87], v[76:79], v[108:111]
    v_mfma_f32_16x16x32_bf16 v[112:115], v[84:87], v[80:83], v[112:115]
    v_mfma_f32_16x16x32_bf16 v[116:119], v[88:91], v[68:71], v[116:119]
    v_mfma_f32_16x16x32_bf16 v[120:123], v[88:91], v[72:75], v[120:123]
    v_mfma_f32_16x16x32_bf16 v[124:127], v[88:91], v[76:79], v[124:127]
    v_mfma_f32_16x16x32_bf16 v[128:131], v[88:91], v[80:83], v[128:131]
    v_mfma_f32_16x16x32_bf16 v[132:135], v[92:95], v[68:71], v[132:135]
    v_mfma_f32_16x16x32_bf16 v[136:139], v[92:95], v[72:75], v[136:139]
    v_mfma_f32_16x16x32_bf16 v[140:143], v[92:95], v[76:79], v[140:143]
    v_mfma_f32_16x16x32_bf16 v[144:147], v[92:95], v[80:83], v[144:147]
    s_waitcnt lgkmcnt(1)
    v_mfma_f32_16x16x32_bf16 v[148:151], v[96:99], v[68:71], v[148:151]
    v_mfma_f32_16x16x32_bf16 v[152:155], v[96:99], v[72:75], v[152:155]
    v_mfma_f32_16x16x32_bf16 v[156:159], v[96:99], v[76:79], v[156:159]
    s_waitcnt lgkmcnt(0)
    s_cmp_lg_u32 s47, 0
    v_mfma_f32_16x16x32_bf16 v[160:163], v[96:99], v[80:83], v[160:163]
    s_cbranch_scc1 L_qk_again
    v_pk_mul_f32 v[100:101], v[100:101], v[32:33]
    v_pk_mul_f32 v[102:103], v[102:103], v[32:33]
    v_pk_mul_f32 v[104:105], v[104:105], v[32:33]
    v_pk_mul_f32 v[106:107], v[106:107], v[32:33]
    v_cvt_pk_bf16_f32 v100, v100, v101
    v_cvt_pk_bf16_f32 v101, v102, v103
    v_cvt_pk_bf16_f32 v102, v104, v105
    v_cvt_pk_bf16_f32 v103, v106, v107
    v_pk_mul_f32 v[108:109], v[108:109], v[32:33]
    v_pk_mul_f32 v[110:111], v[110:111], v[32:33]
    v_pk_mul_f32 v[112:113], v[112:113], v[32:33]
    v_pk_mul_f32 v[114:115], v[114:115], v[32:33]
    v_cvt_pk_bf16_f32 v108, v108, v109
    v_cvt_pk_bf16_f32 v109, v110, v111
    v_cvt_pk_bf16_f32 v110, v112, v113
    v_cvt_pk_bf16_f32 v111, v114, v115
    s_mov_b64 exec, s[72:73]
    v_permlane16_swap_b32 v100, v102
    v_permlane16_swap_b32 v101, v103
    v_permlane16_swap_b32 v108, v110
    v_permlane16_swap_b32 v109, v111
    s_mov_b64 exec, -1
    buffer_store_dwordx4 v[100:103], v28, s[24:27], s70 offen sc1
    buffer_store_dwordx4 v[108:111], v28, s[24:27], s71 offen sc1
    v_pk_mul_f32 v[116:117], v[116:117], v[32:33]
    v_pk_mul_f32 v[118:119], v[118:119], v[32:33]
    v_pk_mul_f32 v[120:121], v[120:121], v[32:33]
    v_pk_mul_f32 v[122:123], v[122:123], v[32:33]
    v_cvt_pk_bf16_f32 v116, v116, v117
    v_cvt_pk_bf16_f32 v117, v118, v119
    v_cvt_pk_bf16_f32 v118, v120, v121
    v_cvt_pk_bf16_f32 v119, v122, v123
    v_pk_mul_f32 v[124:125], v[124:125], v[32:33]
    v_pk_mul_f32 v[126:127], v[126:127], v[32:33]
    v_pk_mul_f32 v[128:129], v[128:129], v[32:33]
    v_pk_mul_f32 v[130:131], v[130:131], v[32:33]
    v_cvt_pk_bf16_f32 v124, v124, v125
    v_cvt_pk_bf16_f32 v125, v126, v127
    v_cvt_pk_bf16_f32 v126, v128, v129
    v_cvt_pk_bf16_f32 v127, v130, v131
    s_mov_b64 exec, s[74:75]
    v_permlane16_swap_b32 v116, v118
    v_permlane16_swap_b32 v117, v119
    v_permlane16_swap_b32 v124, v126
    v_permlane16_swap_b32 v125, v127
    s_mov_b64 exec, -1
    buffer_store_dwordx4 v[116:119], v29, s[24:27], s70 offen sc1
    buffer_store_dwordx4 v[124:127], v29, s[24:27], s71 offen sc1
    v_pk_mul_f32 v[132:133], v[132:133], v[32:33]
    v_pk_mul_f32 v[134:135], v[134:135], v[32:33]
    v_pk_mul_f32 v[136:137], v[136:137], v[32:33]
    v_pk_mul_f32 v[138:139], v[138:139], v[32:33]
    v_cvt_pk_bf16_f32 v132, v132, v133
    v_cvt_pk_bf16_f32 v133, v134, v135
    v_cvt_pk_bf16_f32 v134, v136, v137
    v_cvt_pk_bf16_f32 v135, v138, v139
    v_pk_mul_f32 v[140:141], v[140:141], v[32:33]
    v_pk_mul_f32 v[142:143], v[142:143], v[32:33]
    v_pk_mul_f32 v[144:145], v[144:145], v[32:33]
    v_pk_mul_f32 v[146:147], v[146:147], v[32:33]
    v_cvt_pk_bf16_f32 v140, v140, v141
    v_cvt_pk_bf16_f32 v141, v142, v143
    v_cvt_pk_bf16_f32 v142, v144, v145
    v_cvt_pk_bf16_f32 v143, v146, v147
    s_mov_b64 exec, s[76:77]
    v_permlane16_swap_b32 v132, v134
    v_permlane16_swap_b32 v133, v135
    v_permlane16_swap_b32 v140, v142
    v_permlane16_swap_b32 v141, v143
    s_mov_b64 exec, -1
    buffer_store_dwordx4 v[132:135], v30, s[24:27], s70 offen sc1
    buffer_store_dwordx4 v[140:143], v30, s[24:27], s71 offen sc1
    v_pk_mul_f32 v[148:149], v[148:149], v[32:33]
    v_pk_mul_f32 v[150:151], v[150:151], v[32:33]
    v_pk_mul_f32 v[152:153], v[152:153], v[32:33]
    v_pk_mul_f32 v[154:155], v[154:155], v[32:33]
    v_cvt_pk_bf16_f32 v148, v148, v149
    v_cvt_pk_bf16_f32 v149, v150, v151
    v_cvt_pk_bf16_f32 v150, v152, v153
    v_cvt_pk_bf16_f32 v151, v154, v155
    v_pk_mul_f32 v[156:157], v[156:157], v[32:33]
    v_pk_mul_f32 v[158:159], v[158:159], v[32:33]
    v_pk_mul_f32 v[160:161], v[160:161], v[32:33]
    v_pk_mul_f32 v[162:163], v[162:163], v[32:33]
    v_cvt_pk_bf16_f32 v156, v156, v157
    v_cvt_pk_bf16_f32 v157, v158, v159
    v_cvt_pk_bf16_f32 v158, v160, v161
    v_cvt_pk_bf16_f32 v159, v162, v163
    s_mov_b64 exec, s[78:79]
    v_permlane16_swap_b32 v148, v150
    v_permlane16_swap_b32 v149, v151
    v_permlane16_swap_b32 v156, v158
    v_permlane16_swap_b32 v157, v159
    s_mov_b64 exec, -1
    buffer_store_dwordx4 v[148:151], v31, s[24:27], s70 offen sc1
    buffer_store_dwordx4 v[156:159], v31, s[24:27], s71 offen sc1
    s_branch L_pub
L_vg:
    s_cmp_eq_u32 s67, 15
    s_cbranch_scc1 L_g
    s_mul_i32 s42, s82, 2560
    s_add_u32 s70, s42, 3147008
    s_add_u32 s71, s42, 3149568
    s_sub_u32 s83, s83, 20
    s_lshl_b32 s83, s83, 6
    s_mov_b32 s44, 163840
    s_add_u32 s42, s83, 0
    v_add_u32 v44, s42, v36
    v_mul_u32_u24 v45, 3277, v44
    v_lshrrev_b32 v45, 16, v45
    v_mul_u32_u24 v46, 20, v45
    v_sub_u32 v44, v44, v46
    v_bfe_u32 v46, v44, 2, 2
    v_xor_b32 v46, v46, v37
    v_lshlrev_b32 v46, 4, v46
    v_lshl_add_u32 v44, v44, 6, v46
    v_mad_u32_u24 v28, v45, s44, v44
    s_add_u32 s42, s83, 16
    v_add_u32 v44, s42, v36
    v_mul_u32_u24 v45, 3277, v44
    v_lshrrev_b32 v45, 16, v45
    v_mul_u32_u24 v46, 20, v45
    v_sub_u32 v44, v44, v46
    v_bfe_u32 v46, v44, 2, 2
    v_xor_b32 v46, v46, v37
    v_lshlrev_b32 v46, 4, v46
    v_lshl_add_u32 v44, v44, 6, v46
    v_mad_u32_u24 v29, v45, s44, v44
    s_add_u32 s42, s83, 32
    v_add_u32 v44, s42, v36
    v_mul_u32_u24 v45, 3277, v44
    v_lshrrev_b32 v45, 16, v45
    v_mul_u32_u24 v46, 20, v45
    v_sub_u32 v44, v44, v46
    v_bfe_u32 v46, v44, 2, 2
    v_xor_b32 v46, v46, v37
    v_lshlrev_b32 v46, 4, v46
    v_lshl_add_u32 v44, v44, 6, v46
    v_mad_u32_u24 v30, v45, s44, v44
    s_add_u32 s42, s83, 48
    v_add_u32 v44, s42, v36
    v_mul_u32_u24 v45, 3277, v44
    v_lshrrev_b32 v45, 16, v45
    v_mul_u32_u24 v46, 20, v45
    v_sub_u32 v44, v44, v46
    v_bfe_u32 v46, v44, 2, 2
    v_xor_b32 v46, v46, v37
    v_lshlrev_b32 v46, 4, v46
    v_lshl_add_u32 v44, v44, 6, v46
    v_mad_u32_u24 v31, v45, s44, v44
    s_mov_b32 s47, 9
    s_branch L_v_first
L_v_top:
    s_waitcnt lgkmcnt(9)
    v_mfma_f32_16x16x32_bf16 v[100:103], v[36:39], v[52:55], v[100:103]
    ds_read_b64_tr_b16 v[84:85], v14 offset:24576
    ds_read_b64_tr_b16 v[86:87], v14 offset:25600
    s_cmp_eq_u32 s68, 3
    s_mov_b32 s43, 32768
    s_cmov_b32 s43, -98304
    s_add_u32 s68, s68, 1
    s_and_b32 s68, s68, 3
    s_waitcnt lgkmcnt(10)
    v_mfma_f32_16x16x32_bf16 v[104:107], v[40:43], v[52:55], v[104:107]
    ds_read_b128 v[68:71], v13 offset:0
    s_waitcnt lgkmcnt(10)
    v_mfma_f32_16x16x32_bf16 v[108:111], v[44:47], v[52:55], v[108:111]
    ds_read_b128 v[72:75], v13 offset:2048
    s_waitcnt lgkmcnt(10)
    v_mfma_f32_16x16x32_bf16 v[112:115], v[48:51], v[52:55], v[112:115]
    ds_read_b128 v[76:79], v13 offset:4096
    ds_read_b128 v[80:83], v13 offset:6144
    s_waitcnt lgkmcnt(10)
    v_mfma_f32_16x16x32_bf16 v[116:119], v[36:39], v[56:59], v[116:119]
    ds_read_b64_tr_b16 v[88:89], v15 offset:24576
    v_mfma_f32_16x16x32_bf16 v[120:123], v[40:43], v[56:59], v[120:123]
    ds_read_b64_tr_b16 v[90:91], v15 offset:25600
    v_mfma_f32_16x16x32_bf16 v[124:127], v[44:47], v[56:59], v[124:127]
    ds_read_b64_tr_b16 v[92:93], v16 offset:24576
    ds_read_b64_tr_b16 v[94:95], v16 offset:25600
    v_mfma_f32_16x16x32_bf16 v[128:131], v[48:51], v[56:59], v[128:131]
    ds_read_b64_tr_b16 v[96:97], v17 offset:24576
    s_waitcnt lgkmcnt(13)
    v_mfma_f32_16x16x32_bf16 v[132:135], v[36:39], v[60:63], v[132:135]
    ds_read_b32 v167, v164 offset:36
    ds_read_b64_tr_b16 v[98:99], v17 offset:25600
    s_mov_b64 exec, 1
    ds_add_u32 v164, v165 offset:112
    s_mov_b64 exec, -1
    v_mfma_f32_16x16x32_bf16 v[136:139], v[40:43], v[60:63], v[136:139]
    v_add_u32 v12, s43, v12
    v_add_u32 v13, s43, v13
    v_mfma_f32_16x16x32_bf16 v[140:143], v[44:47], v[60:63], v[140:143]
    v_add_u32 v14, s43, v14
    v_mfma_f32_16x16x32_bf16 v[144:147], v[48:51], v[60:63], v[144:147]
    v_add_u32 v15, s43, v15
    s_waitcnt lgkmcnt(14)
    v_mfma_f32_16x16x32_bf16 v[148:151], v[36:39], v[64:67], v[148:151]
    v_add_u32 v16, s43, v16
    v_mfma_f32_16x16x32_bf16 v[152:155], v[40:43], v[64:67], v[152:155]
    v_add_u32 v17, s43, v17
    s_waitcnt lgkmcnt(2)
    v_readfirstlane_b32 s42, v167
    v_mfma_f32_16x16x32_bf16 v[156:159], v[44:47], v[64:67], v[156:159]
    v_add_u32 v164, 4, v164
    s_min_u32 s42, s42, s47
    s_cmp_eq_u32 s42, 0
    v_mfma_f32_16x16x32_bf16 v[160:163], v[48:51], v[64:67], v[160:163]
    s_cbranch_scc1 L_v_late
    s_sub_u32 s47, s47, 1
    v_mfma_f32_16x16x32_bf16 v[100:103], v[68:71], v[84:87], v[100:103]
    ds_read_b64_tr_b16 v[52:53], v14 offset:16384
    ds_read_b64_tr_b16 v[54:55], v14 offset:17408
    v_mfma_f32_16x16x32_bf16 v[104:107], v[72:75], v[84:87], v[104:107]
    ds_read_b128 v[36:39], v12 offset:0
    v_mfma_f32_16x16x32_bf16 v[108:111], v[76:79], v[84:87], v[108:111]
    ds_read_b128 v[40:43], v12 offset:2048
    v_mfma_f32_16x16x32_bf16 v[112:115], v[80:83], v[84:87], v[112:115]
    ds_read_b128 v[44:47], v12 offset:4096
    ds_read_b128 v[48:51], v12 offset:6144
    v_mfma_f32_16x16x32_bf16 v[116:119], v[68:71], v[88:91], v[116:119]
    ds_read_b64_tr_b16 v[56:57], v15 offset:16384
    v_mfma_f32_16x16x32_bf16 v[120:123], v[72:75], v[88:91], v[120:123]
    ds_read_b64_tr_b16 v[58:59], v15 offset:17408
    v_mfma_f32_16x16x32_bf16 v[124:127], v[76:79], v[88:91], v[124:127]
    ds_read_b64_tr_b16 v[60:61], v16 offset:16384
    ds_read_b64_tr_b16 v[62:63], v16 offset:17408
    v_mfma_f32_16x16x32_bf16 v[128:131], v[80:83], v[88:91], v[128:131]
    ds_read_b64_tr_b16 v[64:65], v17 offset:16384
    v_mfma_f32_16x16x32_bf16 v[132:135], v[68:71], v[92:95], v[132:135]
    ds_read_b64_tr_b16 v[66:67], v17 offset:17408
    v_mfma_f32_16x16x32_bf16 v[136:139], v[72:75], v[92:95], v[136:139]
    v_mfma_f32_16x16x32_bf16 v[140:143], v[76:79], v[92:95], v[140:143]
    v_mfma_f32_16x16x32_bf16 v[144:147], v[80:83], v[92:95], v[144:147]
    s_waitcnt lgkmcnt(13)
    v_mfma_f32_16x16x32_bf16 v[148:151], v[68:71], v[96:99], v[148:151]
    v_mfma_f32_16x16x32_bf16 v[152:155], v[72:75], v[96:99], v[152:155]
    v_mfma_f32_16x16x32_bf16 v[156:159], v[76:79], v[96:99], v[156:159]
    v_mfma_f32_16x16x32_bf16 v[160:163], v[80:83], v[96:99], v[160:163]
    s_branch L_v_top
L_v_again:
    s_sub_u32 s47, s47, 1
L_v_first:
    s_mov_b32 s46, 0x40000
L_poll9:
    ds_read_b32 v167, v164 offset:32
    s_waitcnt lgkmcnt(0)
    v_readfirstlane_b32 s42, v167
    s_cmp_eq_u32 s42, 1
    s_cbranch_scc1 L_got9
    s_sub_u32 s46, s46, 1
    s_cmp_lg_u32 s46, 0
    s_cbranch_scc1 L_poll9
L_got9:
    ds_read_b64_tr_b16 v[52:53], v14 offset:16384
    ds_read_b64_tr_b16 v[54:55], v14 offset:17408
    ds_read_b128 v[36:39], v12 offset:0
    ds_read_b128 v[40:43], v12 offset:2048
    ds_read_b128 v[44:47], v12 offset:4096
    ds_read_b128 v[48:51], v12 offset:6144
    ds_read_b64_tr_b16 v[56:57], v15 offset:16384
    ds_read_b64_tr_b16 v[58:59], v15 offset:17408
    ds_read_b64_tr_b16 v[60:61], v16 offset:16384
    ds_read_b64_tr_b16 v[62:63], v16 offset:17408
    ds_read_b64_tr_b16 v[64:65], v17 offset:16384
    ds_read_b64_tr_b16 v[66:67], v17 offset:17408
    s_branch L_v_top
L_v_late:
    v_mfma_f32_16x16x32_bf16 v[100:103], v[68:71], v[84:87], v[100:103]
    v_mfma_f32_16x16x32_bf16 v[104:107], v[72:75], v[84:87], v[104:107]
    v_mfma_f32_16x16x32_bf16 v[108:111], v[76:79], v[84:87], v[108:111]
    v_mfma_f32_16x16x32_bf16 v[112:115], v[80:83], v[84:87], v[112:115]
    v_mfma_f32_16x16x32_bf16 v[116:119], v[68:71], v[88:91], v[116:119]
    v_mfma_f32_16x16x32_bf16 v[120:123], v[72:75], v[88:91], v[120:123]
    v_mfma_f32_16x16x32_bf16 v[124:127], v[76:79], v[88:91], v[124:127]
    v_mfma_f32_16x16x32_bf16 v[128:131], v[80:83], v[88:91], v[128:131]
    v_mfma_f32_16x16x32_bf16 v[132:135], v[68:71], v[92:95], v[132:135]
    v_mfma_f32_16x16x32_bf16 v[136:139], v[72:75], v[92:95], v[136:139]
    v_mfma_f32_16x16x32_bf16 v[140:143], v[76:79], v[92:95], v[140:143]
    v_mfma_f32_16x16x32_bf16 v[144:147], v[80:83], v[92:95], v[144:147]
    s_waitcnt lgkmcnt(1)
    v_mfma_f32_16x16x32_bf16 v[148:151], v[68:71], v[96:99], v[148:151]
    v_mfma_f32_16x16x32_bf16 v[152:155], v[72:75], v[96:99], v[152:155]
    v_mfma_f32_16x16x32_bf16 v[156:159], v[76:79], v[96:99], v[156:159]
    s_waitcnt lgkmcnt(0)
    s_cmp_lg_u32 s47, 0
    v_mfma_f32_16x16x32_bf16 v[160:163], v[80:83], v[96:99], v[160:163]
    s_cbranch_scc1 L_v_again
    v_cvt_pk_bf16_f32 v100, v100, v101
    v_cvt_pk_bf16_f32 v101, v102, v103
    v_cvt_pk_bf16_f32 v102, v104, v105
    v_cvt_pk_bf16_f32 v103, v106, v107
    v_cvt_pk_bf16_f32 v108, v108, v109
    v_cvt_pk_bf16_f32 v109, v110, v111
    v_cvt_pk_bf16_f32 v110, v112, v113
    v_cvt_pk_bf16_f32 v111, v114, v115
    buffer_store_dwordx4 v[100:103], v28, s[24:27], s70 offen sc1
    buffer_store_dwordx4 v[108:111], v28, s[24:27], s71 offen sc1
    v_cvt_pk_bf16_f32 v116, v116, v117
    v_cvt_pk_bf16_f32 v117, v118, v119
    v_cvt_pk_bf16_f32 v118, v120, v121
    v_cvt_pk_bf16_f32 v119, v122, v123
    v_cvt_pk_bf16_f32 v124, v124, v125
    v_cvt_pk_bf16_f32 v125, v126, v127
    v_cvt_pk_bf16_f32 v126, v128, v129
    v_cvt_pk_bf16_f32 v127, v130, v131
    buffer_store_dwordx4 v[116:119], v29, s[24:27], s70 offen sc1
    buffer_store_dwordx4 v[124:127], v29, s[24:27], s71 offen sc1
    v_cvt_pk_bf16_f32 v132, v132, v133
    v_cvt_pk_bf16_f32 v133, v134, v135
    v_cvt_pk_bf16_f32 v134, v136, v137
    v_cvt_pk_bf16_f32 v135, v138, v139
    v_cvt_pk_bf16_f32 v140, v140, v141
    v_cvt_pk_bf16_f32 v141, v142, v143
    v_cvt_pk_bf16_f32 v142, v144, v145
    v_cvt_pk_bf16_f32 v143, v146, v147
    buffer_store_dwordx4 v[132:135], v30, s[24:27], s70 offen sc1
    buffer_store_dwordx4 v[140:143], v30, s[24:27], s71 offen sc1
    v_cvt_pk_bf16_f32 v148, v148, v149
    v_cvt_pk_bf16_f32 v149, v150, v151
    v_cvt_pk_bf16_f32 v150, v152, v153
    v_cvt_pk_bf16_f32 v151, v154, v155
    v_cvt_pk_bf16_f32 v156, v156, v157
    v_cvt_pk_bf16_f32 v157, v158, v159
    v_cvt_pk_bf16_f32 v158, v160, v161
    v_cvt_pk_bf16_f32 v159, v162, v163
    buffer_store_dwordx4 v[148:151], v31, s[24:27], s70 offen sc1
    buffer_store_dwordx4 v[156:159], v31, s[24:27], s71 offen sc1
    s_branch L_pub
L_g:
    s_mov_b32 s32, s16
    s_mov_b32 s33, s17
    s_mov_b32 s34, 1280
    s_mov_b32 s35, 0x00020000
    s_lshl_b32 s42, s93, 7
    v_lshl_add_u32 v44, v1, 4, s42
    v_add_u32 v45, 1024, v44
    v_subrev_u32 v46, 1280, v44
    v_min_u32 v44, v44, v46
    v_subrev_u32 v46, 1280, v45
    v_min_u32 v45, v45, v46
    s_mov_b32 m0, 30912
    v_lshl_add_u32 v38, v39, 5, v38
    buffer_load_dwordx4 v44, s[32:35], 0 offen lds
    s_mov_b32 m0, 31936
    s_mov_b64 exec, 0xffff
    buffer_load_dwordx4 v45, s[32:35], 0 offen lds
    s_mov_b64 exec, -1
    v_lshlrev_b32 v28, 2, v38
    s_lshl_b32 s42, s82, 7
    s_add_u32 s70, s42, 22020096
    v_lshlrev_b32 v18, 4, v37
    v_add_u32 v18, 30912, v18
    s_waitcnt vmcnt(0)
    s_mov_b32 s47, 9
    s_branch L_g_first
L_g_top:
    s_waitcnt lgkmcnt(3)
    v_mfma_f32_16x16x32_bf16 v[100:103], v[52:55], v[36:39], v[100:103]
    ds_read_b128 v[84:87], v18 offset:64
    ds_read_b128 v[68:71], v13 offset:0
    ds_read_b128 v[72:75], v13 offset:2048
    ds_read_b128 v[76:79], v13 offset:4096
    s_cmp_eq_u32 s68, 3
    s_mov_b32 s43, 32768
    s_cmov_b32 s43, -98304
    s_add_u32 s68, s68, 1
    s_and_b32 s68, s68, 3
    s_waitcnt lgkmcnt(6)
    v_mfma_f32_16x16x32_bf16 v[104:107], v[52:55], v[40:43], v[104:107]
    ds_read_b32 v167, v164 offset:36
    ds_read_b128 v[80:83], v13 offset:6144
    s_mov_b64 exec, 1
    ds_add_u32 v164, v165 offset:112
    s_mov_b64 exec, -1
    s_waitcnt lgkmcnt(2)
    v_readfirstlane_b32 s42, v167
    v_mfma_f32_16x16x32_bf16 v[108:111], v[52:55], v[44:47], v[108:111]
    v_add_u32 v12, s43, v12
    v_add_u32 v13, s43, v13
    v_add_u32 v18, 128, v18
    v_add_u32 v164, 4, v164
    s_min_u32 s42, s42, s47
    s_cmp_eq_u32 s42, 0
    v_mfma_f32_16x16x32_bf16 v[112:115], v[52:55], v[48:51], v[112:115]
    s_cbranch_scc1 L_g_late
    s_sub_u32 s47, s47, 1
    v_mfma_f32_16x16x32_bf16 v[100:103], v[84:87], v[68:71], v[100:103]
    ds_read_b128 v[52:55], v18 offset:0
    ds_read_b128 v[36:39], v12 offset:0
    ds_read_b128 v[40:43], v12 offset:2048
    ds_read_b128 v[44:47], v12 offset:4096
    v_mfma_f32_16x16x32_bf16 v[104:107], v[84:87], v[72:75], v[104:107]
    ds_read_b128 v[48:51], v12 offset:6144
    v_mfma_f32_16x16x32_bf16 v[108:111], v[84:87], v[76:79], v[108:111]
    s_waitcnt lgkmcnt(6)
    v_mfma_f32_16x16x32_bf16 v[112:115], v[84:87], v[80:83], v[112:115]
    s_branch L_g_top
L_g_again:
    s_sub_u32 s47, s47, 1
L_g_first:
    s_mov_b32 s46, 0x40000
L_poll10:
    ds_read_b32 v167, v164 offset:32
    s_waitcnt lgkmcnt(0)
    v_readfirstlane_b32 s42, v167
    s_cmp_eq_u32 s42, 1
    s_cbranch_scc1 L_got10
    s_sub_u32 s46, s46, 1
    s_cmp_lg_u32 s46, 0
    s_cbranch_scc1 L_poll10
L_got10:
    ds_read_b128 v[52:55], v18 offset:0
    ds_read_b128 v[36:39], v12 offset:0
    ds_read_b128 v[40:43], v12 offset:2048
    ds_read_b128 v[44:47], v12 offset:4096
    ds_read_b128 v[48:51], v12 offset:6144
    s_branch L_g_top
L_g_late:
    v_mfma_f32_16x16x32_bf16 v[100:103], v[84:87], v[68:71], v[100:103]
    v_mfma_f32_16x16x32_bf16 v[104:107], v[84:87], v[72:75], v[104:107]
    v_mfma_f32_16x16x32_bf16 v[108:111], v[84:87], v[76:79], v[108:111]
    s_waitcnt lgkmcnt(0)
    s_cmp_lg_u32 s47, 0
    v_mfma_f32_16x16x32_bf16 v[112:115], v[84:87], v[80:83], v[112:115]
    s_cbranch_scc1 L_g_again
    v_lshrrev_b32 v6, 4, v1
    s_nop 0
    v_mov_b32 v7, v100
    v_cmp_eq_u32 vcc, 1, v6
    s_nop 1
    v_cndmask_b32 v7, v7, v104, vcc
    v_cmp_eq_u32 vcc, 2, v6
    s_nop 1
    v_cndmask_b32 v7, v7, v108, vcc
    v_cmp_eq_u32 vcc, 3, v6
    s_nop 1
    v_cndmask_b32 v7, v7, v112, vcc
    v_mul_f32 v7, 0xbfb8aa3b, v7
    v_exp_f32 v7, v7
    s_nop 0
    v_add_f32 v7, 1.0, v7
    v_rcp_f32 v7, v7
    s_nop 0
    buffer_store_dword v7, v28, s[24:27], s70 offen sc1
L_pub:
    v_mov_b32 v164, 163584
    s_mul_i32 s42, s48, 20
    s_add_u32 s43, s42, 19
    s_lshr_b32 s42, s42, 7
    s_lshr_b32 s43, s43, 7
    s_sub_u32 s43, s43, s42
    v_bfe_u32 v36, v1, 3, 1
    v_mad_u32_u24 v36, v36, 5, 5
    v_and_b32 v37, 3, v1
    s_bfe_u32 s44, s2, 0x30003
    s_lshl_b32 s44, s44, 1
    v_and_b32 v38, 1, v1
    v_or_b32 v38, s44, v38
    v_cmp_gt_u32 vcc, 16, v1
    s_nop 1
    v_cndmask_b32 v36, 0, v36, vcc
    v_cndmask_b32 v37, v38, v37, vcc
    v_bfe_u32 v38, v1, 2, 1
    v_and_b32 v38, s43, v38
    v_add3_u32 v36, v36, v38, s42
    v_lshl_add_u32 v36, v36, 4, v37
    v_lshlrev_b32 v36, 7, v36
    s_lshl_b32 s43, s67, 4
    s_add_u32 s43, s43, s66
    s_lshl_b32 s43, s43, 7
    s_lshl_b32 s44, s66, 2
    s_add_u32 s44, s44, 66560
    s_cmp_eq_u32 s67, 15
    s_cselect_b32 s43, s44, s43
    s_add_u32 s43, s43, 22544384
    v_mov_b32 v42, 0x1010101
    s_mov_b32 s44, 22544384
    s_mov_b32 s46, 0x40000
L_poll11:
    ds_read_b32 v167, v164 offset:192
    s_waitcnt lgkmcnt(0)
    v_readfirstlane_b32 s42, v167
    s_cmp_eq_u32 s42, 1
    s_cbranch_scc1 L_got11
    s_sleep 1
    s_sub_u32 s46, s46, 1
    s_cmp_lg_u32 s46, 0
    s_cbranch_scc1 L_poll11
L_got11:
    s_mov_b64 exec, 1
    s_waitcnt vmcnt(0)
    s_mov_b64 exec, 1
    ds_add_rtn_u32 v167, v164, v165 offset:196
    s_mov_b64 exec, -1
    s_waitcnt lgkmcnt(0)
    v_readfirstlane_b32 s45, v167
    s_cmp_lg_u32 s45, 3
    s_cbranch_scc1 L_noflag
    s_mov_b64 exec, 1
    buffer_store_dword v42, off, s[24:27], s43 sc1
    s_mov_b64 exec, 1
    ds_add_u32 v164, v165 offset:196
    s_mov_b64 exec, -1
L_noflag:
    v_lshrrev_b32 v44, 5, v1
    v_bfe_u32 v45, v1, 2, 2
    v_lshl_add_u32 v44, v44, 3, v45
    v_lshlrev_b32 v44, 7, v44
    v_bfe_u32 v45, v1, 4, 1
    v_lshl_add_u32 v44, v45, 5, v44
    v_and_b32 v45, 3, v1
    v_lshl_add_u32 v44, v45, 3, v44
    s_and_b32 s74, s41, 3
    s_lshl_b32 s73, s74, 12
    v_add_u32 v44, s73, v44
    s_lshl_b32 s70, s74, 8
    s_add_u32 s70, s70, s2
    s_mul_i32 s71, s70, 6554
    s_lshr_b32 s71, s71, 16
    s_mul_i32 s73, s71, 10
    s_sub_u32 s72, s70, s73
    s_mul_i32 s74, s72, 272
    s_add_u32 s74, s74, s71
    s_lshl_b32 s74, s74, 10
    s_add_u32 s78, s74, 18874368
    s_add_u32 s70, s70, 1024
    s_mul_i32 s71, s70, 6554
    s_lshr_b32 s71, s71, 16
    s_mul_i32 s73, s71, 10
    s_sub_u32 s72, s70, s73
    s_mul_i32 s74, s72, 272
    s_add_u32 s74, s74, s71
    s_lshl_b32 s74, s74, 10
    s_add_u32 s79, s74, 18874368
    s_mov_b32 s46, 0x40000
L_poll12:
    ds_read_b32 v167, v164 offset:204
    s_waitcnt lgkmcnt(0)
    v_readfirstlane_b32 s42, v167
    s_cmp_eq_u32 s42, 4
    s_cbranch_scc1 L_got12
    s_sleep 2
    s_sub_u32 s46, s46, 1
    s_cmp_lg_u32 s46, 0
    s_cbranch_scc1 L_poll12
L_got12:
    ds_read_b64_tr_b16 v[148:149], v44 offset:0
    ds_read_b64_tr_b16 v[150:151], v44 offset:512
    ds_read_b64_tr_b16 v[152:153], v44 offset:64
    ds_read_b64_tr_b16 v[154:155], v44 offset:576
    ds_read_b64_tr_b16 v[156:157], v44 offset:2048
    ds_read_b64_tr_b16 v[158:159], v44 offset:2560
    ds_read_b64_tr_b16 v[160:161], v44 offset:2112
    ds_read_b64_tr_b16 v[162:163], v44 offset:2624
    s_mov_b64 exec, 1
    ds_add_u32 v164, v165 offset:8
    s_mov_b64 exec, -1
    s_mov_b32 s46, 0x40000
L_poll13:
    ds_read_b32 v167, v164 offset:196
    s_waitcnt lgkmcnt(0)
    v_readfirstlane_b32 s42, v167
    s_cmp_eq_u32 s42, 5
    s_cbranch_scc1 L_got13
    s_sleep 1
    s_sub_u32 s46, s46, 1
    s_cmp_lg_u32 s46, 0
    s_cbranch_scc1 L_poll13
L_got13:
    s_waitcnt lgkmcnt(0)
    v_lshlrev_b32 v44, 4, v1
    s_add_u32 s42, s78, 139264
    buffer_store_dwordx4 v[148:151], v44, s[24:27], s78 offen sc1
    buffer_store_dwordx4 v[152:155], v44, s[24:27], s42 offen sc1
    s_cmp_ge_u32 s70, 1360
    s_cbranch_scc1 L_rput
    s_add_u32 s42, s79, 139264
    buffer_store_dwordx4 v[156:159], v44, s[24:27], s79 offen sc1
    buffer_store_dwordx4 v[160:163], v44, s[24:27], s42 offen sc1
L_rput:
    s_cmp_lg_u32 s45, 0
    s_cbranch_scc1 L_nopre
    s_mov_b64 exec, 0xffffff
    buffer_load_dword v40, v36, s[24:27], s44 offen sc1
    s_waitcnt vmcnt(1)
    s_branch L_iflag
L_nopre:
    s_waitcnt vmcnt(0)
L_iflag:
    s_mov_b64 exec, 1
    ds_add_rtn_u32 v167, v164, v165 offset:212
    s_mov_b64 exec, -1
    s_waitcnt lgkmcnt(0)
    v_readfirstlane_b32 s42, v167
    s_cmp_lg_u32 s42, 3
    s_cbranch_scc1 L_noi
    s_mov_b64 exec, 2
    buffer_store_dword v42, v19, s[24:27], 0 offen sc1
    s_mov_b64 exec, -1
L_noi:
    s_mov_b32 s96, 0
    s_cmp_lg_u32 s45, 0
    s_cbranch_scc1 L_att
    s_mov_b64 exec, 0xffffff
    s_mov_b32 s46, 0x10000
L_flags:
    buffer_load_dword v41, v36, s[24:27], s44 offen sc1
    s_waitcnt vmcnt(1)
    v_cmp_ne_u32 vcc, 0x1010101, v40
    s_cmp_eq_u64 vcc, 0
    s_cbranch_scc1 L_seen
    s_mov_b64 exec, vcc
    s_sleep 2
    buffer_load_dword v40, v36, s[24:27], s44 offen sc1
    s_waitcnt vmcnt(1)
    v_cmp_ne_u32 vcc, 0x1010101, v41
    s_cmp_eq_u64 vcc, 0
    s_cbranch_scc1 L_seen
    s_mov_b64 exec, vcc
    s_sleep 2
    s_sub_u32 s46, s46, 1
    s_cmp_lg_u32 s46, 0
    s_cbranch_scc1 L_flags
L_seen:
    s_mov_b64 exec, 1
    ds_write_b32 v164, v165 offset:28
    s_mov_b64 exec, -1
    s_branch L_att
L_late:
    v_and_b32 v36, 15, v1
    v_lshrrev_b32 v37, 4, v1
    v_bfe_u32 v38, v1, 2, 2
    v_and_b32 v39, 3, v1
    v_lshrrev_b32 v40, 1, v36
    v_xor_b32 v40, v40, v37
    v_lshlrev_b32 v40, 4, v40
    v_lshl_add_u32 v40, v36, 7, v40
    s_lshl_b32 s42, s80, 13
    s_add_u32 s42, s42, 98048
    v_add_u32 v12, s42, v40
    v_xor_b32 v13, 64, v12
    v_lshl_add_u32 v40, v37, 3, v38
    v_and_b32 v41, 1, v37
    s_mov_b32 s68, 2
    v_mul_u32_u24 v40, 192, v40
    v_lshl_add_u32 v40, v39, 3, v40
    v_add_u32 v40, 98048, v40
    s_mul_i32 s42, s81, 3
    s_add_u32 s43, s42, 0
    v_xor_b32 v14, s43, v41
    v_lshl_add_u32 v14, v14, 5, v40
    s_add_u32 s43, s42, 1
    v_xor_b32 v15, s43, v41
    v_lshl_add_u32 v15, v15, 5, v40
    s_add_u32 s43, s42, 2
    v_xor_b32 v16, s43, v41
    v_lshl_add_u32 v16, v16, 5, v40
    v_mov_b32 v32, 0xbfb8aa3b
    v_mov_b32 v34, 1.0
    v_mov_b32 v33, 0xbfb8aa3b
    v_mov_b32 v35, 1.0
    v_and_b32 v40, 12, v36
    v_add_u32 v40, v40, v36
    v_lshl_add_u32 v38, v41, 2, v40
    v_lshrrev_b32 v39, 1, v37
    s_lshl_b32 s82, s66, 2
    s_lshl_b32 s42, s80, 1
    s_add_u32 s82, s82, s42
    s_lshl_b32 s83, s67, 1
    s_add_u32 s83, s83, s81
    v_lshlrev_b32 v28, 4, v38
    v_lshl_add_u32 v28, v39, 9, v28
    s_mul_i32 s42, s82, 96
    s_mul_i32 s43, s83, 3
    s_add_u32 s42, s42, s43
    s_lshl_b32 s42, s42, 10
    s_add_u32 s84, s42, 9437184
    s_add_u32 s85, s42, 9535488
    v_mov_b32 v100, 0
    v_mov_b32 v101, 0
    v_mov_b32 v102, 0
    v_mov_b32 v103, 0
    v_mov_b32 v104, 0
    v_mov_b32 v105, 0
    v_mov_b32 v106, 0
    v_mov_b32 v107, 0
    v_mov_b32 v108, 0
    v_mov_b32 v109, 0
    v_mov_b32 v110, 0
    v_mov_b32 v111, 0
    v_mov_b32 v112, 0
    v_mov_b32 v113, 0
    v_mov_b32 v114, 0
    v_mov_b32 v115, 0
    v_mov_b32 v116, 0
    v_mov_b32 v117, 0
    v_mov_b32 v118, 0
    v_mov_b32 v119, 0
    v_mov_b32 v120, 0
    v_mov_b32 v121, 0
    v_mov_b32 v122, 0
    v_mov_b32 v123, 0
    v_mov_b32 v124, 0
    v_mov_b32 v125, 0
    v_mov_b32 v126, 0
    v_mov_b32 v127, 0
    v_mov_b32 v128, 0
    v_mov_b32 v129, 0
    v_mov_b32 v130, 0
    v_mov_b32 v131, 0
    v_mov_b32 v132, 0
    v_mov_b32 v133, 0
    v_mov_b32 v134, 0
    v_mov_b32 v135, 0
    v_mov_b32 v136, 0
    v_mov_b32 v137, 0
    v_mov_b32 v138, 0
    v_mov_b32 v139, 0
    v_mov_b32 v140, 0
    v_mov_b32 v141, 0
    v_mov_b32 v142, 0
    v_mov_b32 v143, 0
    v_mov_b32 v144, 0
    v_mov_b32 v145, 0
    v_mov_b32 v146, 0
    v_mov_b32 v147, 0
    v_and_b32 v36, 15, v1
    v_lshlrev_b32 v36, 2, v36
    s_waitcnt vmcnt(0)
    s_mov_b64 exec, 1
    ds_add_u32 v164, v165 offset:204
    s_mov_b64 exec, -1
    s_cmp_lg_u32 s41, 2
    s_cbranch_scc1 L_rst
    s_mov_b32 s46, 0x40000
L_poll14:
    ds_read_b32 v167, v164 offset:140
    s_waitcnt lgkmcnt(0)
    v_readfirstlane_b32 s42, v167
    s_cmp_eq_u32 s42, 4
    s_cbranch_scc1 L_got14
    s_sleep 4
    s_sub_u32 s46, s46, 1
    s_cmp_lg_u32 s46, 0
    s_cbranch_scc1 L_poll14
L_got14:
    s_sleep 6
    global_load_dword v37, v36, s[20:21] sc1
    s_mov_b32 s46, 0x10000
    s_waitcnt vmcnt(0)
L_rp:
    v_cmp_ne_u32 vcc, 1, v37
    s_cmp_eq_u64 vcc, 0
    s_cbranch_scc1 L_rs
    s_sleep 16
    global_load_dword v37, v36, s[20:21] sc1
    s_sub_u32 s46, s46, 1
    s_cmp_lg_u32 s46, 0
    s_waitcnt vmcnt(0)
    s_cbranch_scc1 L_rp
L_rs:
    s_mov_b64 exec, 1
    ds_write_b32 v164, v165 offset:192
    s_mov_b64 exec, -1
L_rst:
    v_mov_b32 v164, 163624
    s_mov_b32 s46, 0x40000
L_poll15:
    ds_read_b32 v167, v164 offset:24
    s_waitcnt lgkmcnt(0)
    v_readfirstlane_b32 s42, v167
    s_cmp_eq_u32 s42, 1
    s_cbranch_scc1 L_got15
    s_sleep 8
    s_sub_u32 s46, s46, 1
    s_cmp_lg_u32 s46, 0
    s_cbranch_scc1 L_poll15
L_got15:
    s_setprio 2
    s_mov_b32 s47, 9
    s_branch L_h_first
L_h_top:
    s_waitcnt lgkmcnt(7)
    v_mfma_f32_16x16x32_bf16 v[100:103], v[52:55], v[36:39], v[100:103]
    ds_read_b64_tr_b16 v[84:85], v14 offset:22528
    ds_read_b64_tr_b16 v[86:87], v14 offset:23296
    s_cmp_eq_u32 s68, 3
    s_mov_b32 s43, 32768
    s_cmov_b32 s43, -98304
    s_add_u32 s68, s68, 1
    s_and_b32 s68, s68, 3
    s_waitcnt lgkmcnt(8)
    v_mfma_f32_16x16x32_bf16 v[104:107], v[52:55], v[40:43], v[104:107]
    ds_read_b128 v[68:71], v13 offset:0
    s_waitcnt lgkmcnt(8)
    v_mfma_f32_16x16x32_bf16 v[108:111], v[52:55], v[44:47], v[108:111]
    ds_read_b128 v[72:75], v13 offset:2048
    s_waitcnt lgkmcnt(8)
    v_mfma_f32_16x16x32_bf16 v[112:115], v[52:55], v[48:51], v[112:115]
    ds_read_b128 v[76:79], v13 offset:4096
    ds_read_b128 v[80:83], v13 offset:6144
    s_waitcnt lgkmcnt(8)
    v_mfma_f32_16x16x32_bf16 v[116:119], v[56:59], v[36:39], v[116:119]
    ds_read_b32 v167, v164 offset:36
    ds_read_b64_tr_b16 v[88:89], v15 offset:22528
    v_mfma_f32_16x16x32_bf16 v[120:123], v[56:59], v[40:43], v[120:123]
    ds_read_b64_tr_b16 v[90:91], v15 offset:23296
    v_mfma_f32_16x16x32_bf16 v[124:127], v[56:59], v[44:47], v[124:127]
    ds_read_b64_tr_b16 v[92:93], v16 offset:22528
    ds_read_b64_tr_b16 v[94:95], v16 offset:23296
    s_mov_b64 exec, 1
    ds_add_u32 v164, v165 offset:112
    s_mov_b64 exec, -1
    v_mfma_f32_16x16x32_bf16 v[128:131], v[56:59], v[48:51], v[128:131]
    v_add_u32 v12, s43, v12
    v_add_u32 v13, s43, v13
    s_waitcnt lgkmcnt(12)
    v_mfma_f32_16x16x32_bf16 v[132:135], v[60:63], v[36:39], v[132:135]
    v_add_u32 v14, s43, v14
    v_mfma_f32_16x16x32_bf16 v[136:139], v[60:63], v[40:43], v[136:139]
    v_add_u32 v15, s43, v15
    v_add_u32 v16, s43, v16
    s_waitcnt lgkmcnt(5)
    v_readfirstlane_b32 s42, v167
    v_mfma_f32_16x16x32_bf16 v[140:143], v[60:63], v[44:47], v[140:143]
    v_add_u32 v164, 4, v164
    s_min_u32 s42, s42, s47
    s_cmp_eq_u32 s42, 0
    v_mfma_f32_16x16x32_bf16 v[144:147], v[60:63], v[48:51], v[144:147]
    s_cbranch_scc1 L_h_late
    s_sub_u32 s47, s47, 1
    v_mfma_f32_16x16x32_bf16 v[100:103], v[84:87], v[68:71], v[100:103]
    ds_read_b64_tr_b16 v[52:53], v14 offset:16384
    ds_read_b64_tr_b16 v[54:55], v14 offset:17152
    v_mfma_f32_16x16x32_bf16 v[104:107], v[84:87], v[72:75], v[104:107]
    ds_read_b128 v[36:39], v12 offset:0
    v_mfma_f32_16x16x32_bf16 v[108:111], v[84:87], v[76:79], v[108:111]
    ds_read_b128 v[40:43], v12 offset:2048
    v_mfma_f32_16x16x32_bf16 v[112:115], v[84:87], v[80:83], v[112:115]
    ds_read_b128 v[44:47], v12 offset:4096
    ds_read_b128 v[48:51], v12 offset:6144
    s_waitcnt lgkmcnt(9)
    v_mfma_f32_16x16x32_bf16 v[116:119], v[88:91], v[68:71], v[116:119]
    ds_read_b64_tr_b16 v[56:57], v15 offset:16384
    v_mfma_f32_16x16x32_bf16 v[120:123], v[88:91], v[72:75], v[120:123]
    ds_read_b64_tr_b16 v[58:59], v15 offset:17152
    v_mfma_f32_16x16x32_bf16 v[124:127], v[88:91], v[76:79], v[124:127]
    ds_read_b64_tr_b16 v[60:61], v16 offset:16384
    ds_read_b64_tr_b16 v[62:63], v16 offset:17152
    v_mfma_f32_16x16x32_bf16 v[128:131], v[88:91], v[80:83], v[128:131]
    s_waitcnt lgkmcnt(11)
    v_mfma_f32_16x16x32_bf16 v[132:135], v[92:95], v[68:71], v[132:135]
    v_mfma_f32_16x16x32_bf16 v[136:139], v[92:95], v[72:75], v[136:139]
    v_mfma_f32_16x16x32_bf16 v[140:143], v[92:95], v[76:79], v[140:143]
    v_mfma_f32_16x16x32_bf16 v[144:147], v[92:95], v[80:83], v[144:147]
    s_branch L_h_top
L_h_again:
    s_sub_u32 s47, s47, 1
L_h_first:
    s_mov_b32 s46, 0x40000
L_poll16:
    ds_read_b32 v167, v164 offset:32
    s_waitcnt lgkmcnt(0)
    v_readfirstlane_b32 s42, v167
    s_cmp_eq_u32 s42, 1
    s_cbranch_scc1 L_got16
    s_sub_u32 s46, s46, 1
    s_cmp_lg_u32 s46, 0
    s_cbranch_scc1 L_poll16
L_got16:
    ds_read_b64_tr_b16 v[52:53], v14 offset:16384
    ds_read_b64_tr_b16 v[54:55], v14 offset:17152
    ds_read_b128 v[36:39], v12 offset:0
    ds_read_b128 v[40:43], v12 offset:2048
    ds_read_b128 v[44:47], v12 offset:4096
    ds_read_b128 v[48:51], v12 offset:6144
    ds_read_b64_tr_b16 v[56:57], v15 offset:16384
    ds_read_b64_tr_b16 v[58:59], v15 offset:17152
    ds_read_b64_tr_b16 v[60:61], v16 offset:16384
    ds_read_b64_tr_b16 v[62:63], v16 offset:17152
    s_branch L_h_top
L_h_late:
    v_mfma_f32_16x16x32_bf16 v[100:103], v[84:87], v[68:71], v[100:103]
    v_mfma_f32_16x16x32_bf16 v[104:107], v[84:87], v[72:75], v[104:107]
    v_mfma_f32_16x16x32_bf16 v[108:111], v[84:87], v[76:79], v[108:111]
    v_mfma_f32_16x16x32_bf16 v[112:115], v[84:87], v[80:83], v[112:115]
    s_waitcnt lgkmcnt(3)
    v_mfma_f32_16x16x32_bf16 v[116:119], v[88:91], v[68:71], v[116:119]
    v_mfma_f32_16x16x32_bf16 v[120:123], v[88:91], v[72:75], v[120:123]
    v_mfma_f32_16x16x32_bf16 v[124:127], v[88:91], v[76:79], v[124:127]
    v_mfma_f32_16x16x32_bf16 v[128:131], v[88:91], v[80:83], v[128:131]
    s_waitcnt lgkmcnt(1)
    v_mfma_f32_16x16x32_bf16 v[132:135], v[92:95], v[68:71], v[132:135]
    v_mfma_f32_16x16x32_bf16 v[136:139], v[92:95], v[72:75], v[136:139]
    v_mfma_f32_16x16x32_bf16 v[140:143], v[92:95], v[76:79], v[140:143]
    s_waitcnt lgkmcnt(0)
    s_cmp_lg_u32 s47, 0
    v_mfma_f32_16x16x32_bf16 v[144:147], v[92:95], v[80:83], v[144:147]
    s_cbranch_scc1 L_h_again
    s_setprio 3
    v_mov_b32 v164, 163584
    ds_read_b32 v167, v164 offset:28
    s_waitcnt lgkmcnt(0)
    v_readfirstlane_b32 s95, v167
    s_cmp_eq_u32 s95, 0
    s_cbranch_scc1 L_silu
    buffer_load_dwordx4 v[12:15], v2, s[24:27], s94 offen sc1
    buffer_load_dwordx4 v[20:23], v2, s[24:27], s51 offen sc1
    buffer_load_dword v16, v3, s[24:27], s94 offen sc1
    buffer_load_dword v24, v3, s[24:27], s51 offen sc1
L_silu:
    v_pk_mul_f32 v[36:37], v[100:101], v[32:33]
    v_pk_mul_f32 v[38:39], v[102:103], v[32:33]
    v_pk_mul_f32 v[40:41], v[104:105], v[32:33]
    v_pk_mul_f32 v[42:43], v[106:107], v[32:33]
    v_exp_f32 v36, v36
    v_exp_f32 v37, v37
    v_exp_f32 v38, v38
    v_exp_f32 v39, v39
    v_exp_f32 v40, v40
    v_exp_f32 v41, v41
    v_exp_f32 v42, v42
    v_exp_f32 v43, v43
    v_pk_add_f32 v[36:37], v[36:37], v[34:35]
    v_pk_add_f32 v[38:39], v[38:39], v[34:35]
    v_pk_add_f32 v[40:41], v[40:41], v[34:35]
    v_pk_add_f32 v[42:43], v[42:43], v[34:35]
    v_rcp_f32 v36, v36
    v_rcp_f32 v37, v37
    v_rcp_f32 v38, v38
    v_rcp_f32 v39, v39
    v_rcp_f32 v40, v40
    v_rcp_f32 v41, v41
    v_rcp_f32 v42, v42
    v_rcp_f32 v43, v43
    v_pk_mul_f32 v[36:37], v[36:37], v[100:101]
    v_pk_mul_f32 v[38:39], v[38:39], v[102:103]
    v_pk_mul_f32 v[40:41], v[40:41], v[104:105]
    v_pk_mul_f32 v[42:43], v[42:43], v[106:107]
    v_cvt_pk_bf16_f32 v100, v36, v37
    v_cvt_pk_bf16_f32 v101, v38, v39
    v_cvt_pk_bf16_f32 v102, v40, v41
    v_cvt_pk_bf16_f32 v103, v42, v43
    s_nop 0
    v_permlane16_swap_b32 v100, v102
    v_permlane16_swap_b32 v101, v103
    buffer_store_dwordx4 v[100:103], v28, s[24:27], s84 offen offset:0 sc1
    v_pk_mul_f32 v[44:45], v[108:109], v[32:33]
    v_pk_mul_f32 v[46:47], v[110:111], v[32:33]
    v_pk_mul_f32 v[48:49], v[112:113], v[32:33]
    v_pk_mul_f32 v[50:51], v[114:115], v[32:33]
    v_exp_f32 v44, v44
    v_exp_f32 v45, v45
    v_exp_f32 v46, v46
    v_exp_f32 v47, v47
    v_exp_f32 v48, v48
    v_exp_f32 v49, v49
    v_exp_f32 v50, v50
    v_exp_f32 v51, v51
    v_pk_add_f32 v[44:45], v[44:45], v[34:35]
    v_pk_add_f32 v[46:47], v[46:47], v[34:35]
    v_pk_add_f32 v[48:49], v[48:49], v[34:35]
    v_pk_add_f32 v[50:51], v[50:51], v[34:35]
    v_rcp_f32 v44, v44
    v_rcp_f32 v45, v45
    v_rcp_f32 v46, v46
    v_rcp_f32 v47, v47
    v_rcp_f32 v48, v48
    v_rcp_f32 v49, v49
    v_rcp_f32 v50, v50
    v_rcp_f32 v51, v51
    v_pk_mul_f32 v[44:45], v[44:45], v[108:109]
    v_pk_mul_f32 v[46:47], v[46:47], v[110:111]
    v_pk_mul_f32 v[48:49], v[48:49], v[112:113]
    v_pk_mul_f32 v[50:51], v[50:51], v[114:115]
    v_cvt_pk_bf16_f32 v108, v44, v45
    v_cvt_pk_bf16_f32 v109, v46, v47
    v_cvt_pk_bf16_f32 v110, v48, v49
    v_cvt_pk_bf16_f32 v111, v50, v51
    s_nop 0
    v_permlane16_swap_b32 v108, v110
    v_permlane16_swap_b32 v109, v111
    buffer_store_dwordx4 v[108:111], v28, s[24:27], s85 offen offset:0 sc1
    v_pk_mul_f32 v[36:37], v[116:117], v[32:33]
    v_pk_mul_f32 v[38:39], v[118:119], v[32:33]
    v_pk_mul_f32 v[40:41], v[120:121], v[32:33]
    v_pk_mul_f32 v[42:43], v[122:123], v[32:33]
    v_exp_f32 v36, v36
    v_exp_f32 v37, v37
    v_exp_f32 v38, v38
    v_exp_f32 v39, v39
    v_exp_f32 v40, v40
    v_exp_f32 v41, v41
    v_exp_f32 v42, v42
    v_exp_f32 v43, v43
    v_pk_add_f32 v[36:37], v[36:37], v[34:35]
    v_pk_add_f32 v[38:39], v[38:39], v[34:35]
    v_pk_add_f32 v[40:41], v[40:41], v[34:35]
    v_pk_add_f32 v[42:43], v[42:43], v[34:35]
    v_rcp_f32 v36, v36
    v_rcp_f32 v37, v37
    v_rcp_f32 v38, v38
    v_rcp_f32 v39, v39
    v_rcp_f32 v40, v40
    v_rcp_f32 v41, v41
    v_rcp_f32 v42, v42
    v_rcp_f32 v43, v43
    v_pk_mul_f32 v[36:37], v[36:37], v[116:117]
    v_pk_mul_f32 v[38:39], v[38:39], v[118:119]
    v_pk_mul_f32 v[40:41], v[40:41], v[120:121]
    v_pk_mul_f32 v[42:43], v[42:43], v[122:123]
    v_cvt_pk_bf16_f32 v116, v36, v37
    v_cvt_pk_bf16_f32 v117, v38, v39
    v_cvt_pk_bf16_f32 v118, v40, v41
    v_cvt_pk_bf16_f32 v119, v42, v43
    s_nop 0
    v_permlane16_swap_b32 v116, v118
    v_permlane16_swap_b32 v117, v119
    buffer_store_dwordx4 v[116:119], v28, s[24:27], s84 offen offset:1024 sc1
    v_pk_mul_f32 v[44:45], v[124:125], v[32:33]
    v_pk_mul_f32 v[46:47], v[126:127], v[32:33]
    v_pk_mul_f32 v[48:49], v[128:129], v[32:33]
    v_pk_mul_f32 v[50:51], v[130:131], v[32:33]
    v_exp_f32 v44, v44
    v_exp_f32 v45, v45
    v_exp_f32 v46, v46
    v_exp_f32 v47, v47
    v_exp_f32 v48, v48
    v_exp_f32 v49, v49
    v_exp_f32 v50, v50
    v_exp_f32 v51, v51
    v_pk_add_f32 v[44:45], v[44:45], v[34:35]
    v_pk_add_f32 v[46:47], v[46:47], v[34:35]
    v_pk_add_f32 v[48:49], v[48:49], v[34:35]
    v_pk_add_f32 v[50:51], v[50:51], v[34:35]
    v_rcp_f32 v44, v44
    v_rcp_f32 v45, v45
    v_rcp_f32 v46, v46
    v_rcp_f32 v47, v47
    v_rcp_f32 v48, v48
    v_rcp_f32 v49, v49
    v_rcp_f32 v50, v50
    v_rcp_f32 v51, v51
    v_pk_mul_f32 v[44:45], v[44:45], v[124:125]
    v_pk_mul_f32 v[46:47], v[46:47], v[126:127]
    v_pk_mul_f32 v[48:49], v[48:49], v[128:129]
    v_pk_mul_f32 v[50:51], v[50:51], v[130:131]
    v_cvt_pk_bf16_f32 v124, v44, v45
    v_cvt_pk_bf16_f32 v125, v46, v47
    v_cvt_pk_bf16_f32 v126, v48, v49
    v_cvt_pk_bf16_f32 v127, v50, v51
    s_nop 0
    v_permlane16_swap_b32 v124, v126
    v_permlane16_swap_b32 v125, v127
    buffer_store_dwordx4 v[124:127], v28, s[24:27], s85 offen offset:1024 sc1
    v_pk_mul_f32 v[36:37], v[132:133], v[32:33]
    v_pk_mul_f32 v[38:39], v[134:135], v[32:33]
    v_pk_mul_f32 v[40:41], v[136:137], v[32:33]
    v_pk_mul_f32 v[42:43], v[138:139], v[32:33]
    v_exp_f32 v36, v36
    v_exp_f32 v37, v37
    v_exp_f32 v38, v38
    v_exp_f32 v39, v39
    v_exp_f32 v40, v40
    v_exp_f32 v41, v41
    v_exp_f32 v42, v42
    v_exp_f32 v43, v43
    v_pk_add_f32 v[36:37], v[36:37], v[34:35]
    v_pk_add_f32 v[38:39], v[38:39], v[34:35]
    v_pk_add_f32 v[40:41], v[40:41], v[34:35]
    v_pk_add_f32 v[42:43], v[42:43], v[34:35]
    v_rcp_f32 v36, v36
    v_rcp_f32 v37, v37
    v_rcp_f32 v38, v38
    v_rcp_f32 v39, v39
    v_rcp_f32 v40, v40
    v_rcp_f32 v41, v41
    v_rcp_f32 v42, v42
    v_rcp_f32 v43, v43
    v_pk_mul_f32 v[36:37], v[36:37], v[132:133]
    v_pk_mul_f32 v[38:39], v[38:39], v[134:135]
    v_pk_mul_f32 v[40:41], v[40:41], v[136:137]
    v_pk_mul_f32 v[42:43], v[42:43], v[138:139]
    v_cvt_pk_bf16_f32 v132, v36, v37
    v_cvt_pk_bf16_f32 v133, v38, v39
    v_cvt_pk_bf16_f32 v134, v40, v41
    v_cvt_pk_bf16_f32 v135, v42, v43
    s_nop 0
    v_permlane16_swap_b32 v132, v134
    v_permlane16_swap_b32 v133, v135
    buffer_store_dwordx4 v[132:135], v28, s[24:27], s84 offen offset:2048 sc1
    v_pk_mul_f32 v[44:45], v[140:141], v[32:33]
    v_pk_mul_f32 v[46:47], v[142:143], v[32:33]
    v_pk_mul_f32 v[48:49], v[144:145], v[32:33]
    v_pk_mul_f32 v[50:51], v[146:147], v[32:33]
    v_exp_f32 v44, v44
    v_exp_f32 v45, v45
    v_exp_f32 v46, v46
    v_exp_f32 v47, v47
    v_exp_f32 v48, v48
    v_exp_f32 v49, v49
    v_exp_f32 v50, v50
    v_exp_f32 v51, v51
    v_pk_add_f32 v[44:45], v[44:45], v[34:35]
    v_pk_add_f32 v[46:47], v[46:47], v[34:35]
    v_pk_add_f32 v[48:49], v[48:49], v[34:35]
    v_pk_add_f32 v[50:51], v[50:51], v[34:35]
    v_rcp_f32 v44, v44
    v_rcp_f32 v45, v45
    v_rcp_f32 v46, v46
    v_rcp_f32 v47, v47
    v_rcp_f32 v48, v48
    v_rcp_f32 v49, v49
    v_rcp_f32 v50, v50
    v_rcp_f32 v51, v51
    v_pk_mul_f32 v[44:45], v[44:45], v[140:141]
    v_pk_mul_f32 v[46:47], v[46:47], v[142:143]
    v_pk_mul_f32 v[48:49], v[48:49], v[144:145]
    v_pk_mul_f32 v[50:51], v[50:51], v[146:147]
    v_cvt_pk_bf16_f32 v140, v44, v45
    v_cvt_pk_bf16_f32 v141, v46, v47
    v_cvt_pk_bf16_f32 v142, v48, v49
    v_cvt_pk_bf16_f32 v143, v50, v51
    s_nop 0
    v_permlane16_swap_b32 v140, v142
    v_permlane16_swap_b32 v141, v143
    buffer_store_dwordx4 v[140:143], v28, s[24:27], s85 offen offset:2048 sc1
    s_mov_b64 exec, 1
    ds_add_u32 v164, v165 offset:200
    s_mov_b64 exec, -1
L_att:
    v_mov_b32 v25, 0x3f80
    v_mov_b32 v17, 0
    v_mov_b32 v26, 0xdddddddd
    v_and_b32 v27, 31, v1
    v_lshlrev_b32 v27, 2, v27
    v_mov_b32 v32, 0
    v_mov_b32 v33, 0
    v_mov_b32 v34, 0
    v_mov_b32 v35, 0
    v_mov_b32 v68, 0
    v_mov_b32 v69, 0
    v_mov_b32 v70, 0
    v_mov_b32 v71, 0
    v_mov_b32 v72, 0
    v_mov_b32 v73, 0
    v_mov_b32 v74, 0
    v_mov_b32 v75, 0
    v_mov_b32 v76, 0
    v_mov_b32 v77, 0
    v_mov_b32 v78, 0
    v_mov_b32 v79, 0
    v_mov_b32 v80, 0
    v_mov_b32 v81, 0
    v_mov_b32 v82, 0
    v_mov_b32 v83, 0
    v_mov_b32 v60, 0
    v_mov_b32 v61, 0
    v_mov_b32 v62, 0
    v_mov_b32 v63, 0
    v_mov_b32 v64, 0
    v_mov_b32 v65, 0
    v_mov_b32 v66, 0
    v_mov_b32 v67, 0
    s_mov_b32 s47, 0
    s_cmp_lt_u32 s41, 4
    s_cbranch_scc1 L_hpub
    s_and_b32 s43, s41, 3
    s_mul_i32 s50, s43, 2560
    s_add_u32 s50, s50, s51
    s_add_u32 s50, s50, 1280
    s_mul_i32 s43, s43, 2576
    s_add_u32 s43, s43, 16
    v_mov_b32 v52, 0x3f803f80
    v_mov_b32 v53, 0x3f803f80
    v_mov_b32 v54, 0x3f803f80
    v_mov_b32 v55, 0x3f803f80
    v_min_u32 v6, 11, v1
    v_mul_u32_u24 v6, 2576, v6
    s_mov_b32 s46, 0x40000
L_poll17:
    ds_read_b32 v7, v164 offset:8
    s_waitcnt lgkmcnt(0)
    v_readfirstlane_b32 s42, v7
    s_cmp_eq_u32 s42, 4
    s_cbranch_scc1 L_got17
    s_sleep 1
    s_sub_u32 s46, s46, 1
    s_cmp_lg_u32 s46, 0
    s_cbranch_scc1 L_poll17
L_got17:
    s_mov_b64 exec, 0xfff
    ds_write_b128 v6, v[52:55]
    s_mov_b64 exec, -1
    s_mov_b32 s46, 0x40000
L_poll18:
    ds_read_b32 v6, v164 offset:28
    s_waitcnt lgkmcnt(0)
    v_readfirstlane_b32 s42, v6
    s_cmp_eq_u32 s42, 1
    s_cbranch_scc1 L_got18
    s_sleep 1
    s_sub_u32 s46, s46, 1
    s_cmp_lg_u32 s46, 0
    s_cbranch_scc1 L_poll18
L_got18:
    buffer_load_dwordx4 v[12:15], v2, s[24:27], s94 offen sc1
    buffer_load_dwordx4 v[20:23], v2, s[24:27], s51 offen sc1
    buffer_load_dword v16, v3, s[24:27], s94 offen sc1
    buffer_load_dword v24, v3, s[24:27], s51 offen sc1
    s_add_u32 m0, s43, 0
    s_add_u32 s42, s50, 0
    buffer_load_dwordx4 v2, s[24:27], s42 offen sc1 lds
    buffer_load_dwordx4 v2, s[24:27], s42 offen offset:1024 sc1 lds
    s_mov_b32 exec_hi, 0
    buffer_load_dwordx4 v2, s[24:27], s42 offen offset:2048 sc1 lds
    s_mov_b64 exec, -1
    s_add_u32 m0, s43, 10304
    s_add_u32 s42, s50, 10240
    buffer_load_dwordx4 v2, s[24:27], s42 offen sc1 lds
    buffer_load_dwordx4 v2, s[24:27], s42 offen offset:1024 sc1 lds
    s_mov_b32 exec_hi, 0
    buffer_load_dwordx4 v2, s[24:27], s42 offen offset:2048 sc1 lds
    s_mov_b64 exec, -1
    s_add_u32 m0, s43, 20608
    s_add_u32 s42, s50, 20480
    buffer_load_dwordx4 v2, s[24:27], s42 offen sc1 lds
    buffer_load_dwordx4 v2, s[24:27], s42 offen offset:1024 sc1 lds
    s_mov_b32 exec_hi, 0
    buffer_load_dwordx4 v2, s[24:27], s42 offen offset:2048 sc1 lds
    s_mov_b64 exec, -1
    s_waitcnt vmcnt(9)
L_first:
    v_mfma_f32_32x32x16_bf16 v[36:51], v[20:23], v[12:15], 0
    v_mfma_f32_32x32x8_bf16 v[36:51], v[24:25], v[16:17], v[36:51]
    v_add_u32 v2, 3872, v2
    v_add_u32 v3, 3872, v3
    s_nop 9
    v_max3_f32 v11, v36, v37, v38
    v_max_f32 v11, v11, v39
    v_max3_f32 v11, v11, v40, v41
    v_max3_f32 v11, v11, v42, v43
    v_max3_f32 v11, v11, v44, v45
    v_max3_f32 v11, v11, v46, v47
    v_max3_f32 v11, v11, v48, v49
    v_max3_f32 v11, v11, v50, v51
    v_mov_b32 v6, v11
    s_nop 1
    v_permlane32_swap_b32 v11, v6
    v_max_f32 v11, v11, v6
    v_cvt_pk_bf16_f32 v11, -v11, 0
    v_cmp_gt_u32 vcc, 32, v1
    s_nop 1
    v_cndmask_b32 v17, 0, v11, vcc
    v_mfma_f32_32x32x16_bf16 v[36:51], v[20:23], v[12:15], 0
    s_nop 0
    v_mfma_f32_32x32x8_bf16 v[36:51], v[24:25], v[16:17], v[36:51]
    s_cmp_lt_u32 s41, 4
    s_cbranch_scc1 L_nofill
    s_waitcnt vmcnt(0)
    s_mov_b64 exec, 1
    ds_add_u32 v164, v165 offset:0
    s_mov_b64 exec, -1
L_nofill:
    s_mov_b32 s46, 0x40000
L_poll19:
    ds_read_b32 v6, v164 offset:0
    s_waitcnt lgkmcnt(0)
    v_readfirstlane_b32 s42, v6
    s_cmp_eq_u32 s42, 4
    s_cbranch_scc1 L_got19
    s_sub_u32 s46, s46, 1
    s_cmp_lg_u32 s46, 0
    s_cbranch_scc1 L_poll19
L_got19:
    v_subrev_u32 v6, 2576, v2
    v_subrev_u32 v7, 2576, v3
    ds_read_b128 v[20:23], v6
    ds_read_b32 v24, v7
    ds_read_b128 v[28:31], v4
    v_add_u32 v4, 2576, v4
    s_lshl_b32 s44, s49, 7
    s_add_u32 s44, s44, 22020096
    s_waitcnt lgkmcnt(0)
L_loop:
    s_setprio 3
    v_exp_f32 v36, v36
    v_smfmac_f32_32x32x32_bf16 v[68:83], v[32:35], v[60:67], v26
    ds_read_b128 v[32:35], v5 offset:0
    v_exp_f32 v37, v37
    v_exp_f32 v38, v38
    v_exp_f32 v39, v39
    v_exp_f32 v40, v40
    v_mfma_f32_32x32x16_bf16 v[52:67], v[20:23], v[12:15], 0
    ds_read_b128 v[20:23], v2 offset:0
    v_exp_f32 v41, v41
    v_exp_f32 v42, v42
    v_exp_f32 v43, v43
    s_waitcnt lgkmcnt(2)
    v_exp_f32 v44, v44
    v_mfma_f32_32x32x8_bf16 v[52:67], v[24:25], v[16:17], v[52:67]
    ds_read_b32 v24, v3 offset:0
    v_exp_f32 v45, v45
    v_exp_f32 v46, v46
    v_exp_f32 v47, v47
    v_exp_f32 v48, v48
    v_smfmac_f32_32x32x32_bf16 v[68:83], v[28:31], v[36:43], v26
    ds_read_b128 v[28:31], v4 offset:0
    v_exp_f32 v49, v49
    v_exp_f32 v50, v50
    v_exp_f32 v51, v51
    s_waitcnt lgkmcnt(2)
    s_nop 0
    v_exp_f32 v52, v52
    v_smfmac_f32_32x32x32_bf16 v[68:83], v[32:35], v[44:51], v26
    ds_read_b128 v[32:35], v5 offset:2576
    v_exp_f32 v53, v53
    v_exp_f32 v54, v54
    v_exp_f32 v55, v55
    v_exp_f32 v56, v56
    v_mfma_f32_32x32x16_bf16 v[36:51], v[20:23], v[12:15], 0
    ds_read_b128 v[20:23], v2 offset:2576
    v_exp_f32 v57, v57
    v_exp_f32 v58, v58
    v_exp_f32 v59, v59
    s_waitcnt lgkmcnt(2)
    v_exp_f32 v60, v60
    v_mfma_f32_32x32x8_bf16 v[36:51], v[24:25], v[16:17], v[36:51]
    ds_read_b32 v24, v3 offset:2576
    v_exp_f32 v61, v61
    v_exp_f32 v62, v62
    v_exp_f32 v63, v63
    v_exp_f32 v64, v64
    v_smfmac_f32_32x32x32_bf16 v[68:83], v[28:31], v[52:59], v26
    ds_read_b128 v[28:31], v4 offset:2576
    v_exp_f32 v65, v65
    v_exp_f32 v66, v66
    v_exp_f32 v67, v67
    s_waitcnt lgkmcnt(2)
    s_nop 0
    v_exp_f32 v36, v36
    v_smfmac_f32_32x32x32_bf16 v[68:83], v[32:35], v[60:67], v26
    ds_read_b128 v[32:35], v5 offset:5152
    v_exp_f32 v37, v37
    v_exp_f32 v38, v38
    v_exp_f32 v39, v39
    v_exp_f32 v40, v40
    v_mfma_f32_32x32x16_bf16 v[52:67], v[20:23], v[12:15], 0
    ds_read_b128 v[20:23], v2 offset:5152
    v_exp_f32 v41, v41
    v_exp_f32 v42, v42
    v_exp_f32 v43, v43
    s_waitcnt lgkmcnt(2)
    v_exp_f32 v44, v44
    v_mfma_f32_32x32x8_bf16 v[52:67], v[24:25], v[16:17], v[52:67]
    ds_read_b32 v24, v3 offset:5152
    v_exp_f32 v45, v45
    v_exp_f32 v46, v46
    v_exp_f32 v47, v47
    v_exp_f32 v48, v48
    v_smfmac_f32_32x32x32_bf16 v[68:83], v[28:31], v[36:43], v26
    ds_read_b128 v[28:31], v4 offset:5152
    v_exp_f32 v49, v49
    v_exp_f32 v50, v50
    v_exp_f32 v51, v51
    s_waitcnt lgkmcnt(2)
    s_cmp_lt_u32 s47, 3
    s_cbranch_scc1 L_hook
L_hret:
    s_setprio 2
    v_exp_f32 v52, v52
    v_smfmac_f32_32x32x32_bf16 v[68:83], v[32:35], v[44:51], v26
    ds_read_b128 v[32:35], v5 offset:7728
    v_exp_f32 v53, v53
    v_exp_f32 v54, v54
    v_exp_f32 v55, v55
    v_exp_f32 v56, v56
    v_mfma_f32_32x32x16_bf16 v[36:51], v[20:23], v[12:15], 0
    ds_read_b128 v[20:23], v2 offset:7728
    v_exp_f32 v57, v57
    v_exp_f32 v58, v58
    v_exp_f32 v59, v59
    s_waitcnt lgkmcnt(2)
    v_exp_f32 v60, v60
    v_mfma_f32_32x32x8_bf16 v[36:51], v[24:25], v[16:17], v[36:51]
    ds_read_b32 v24, v3 offset:7728
    v_exp_f32 v61, v61
    v_exp_f32 v62, v62
    v_exp_f32 v63, v63
    v_exp_f32 v64, v64
    v_smfmac_f32_32x32x32_bf16 v[68:83], v[28:31], v[52:59], v26
    ds_read_b128 v[28:31], v4 offset:7728
    v_exp_f32 v65, v65
    v_exp_f32 v66, v66
    v_exp_f32 v67, v67
    s_waitcnt lgkmcnt(2)
    s_nop 0
    v_exp_f32 v36, v36
    v_smfmac_f32_32x32x32_bf16 v[68:83], v[32:35], v[60:67], v26
    ds_read_b128 v[32:35], v5 offset:10304
    v_exp_f32 v37, v37
    v_exp_f32 v38, v38
    v_exp_f32 v39, v39
    v_exp_f32 v40, v40
    v_mfma_f32_32x32x16_bf16 v[52:67], v[20:23], v[12:15], 0
    ds_read_b128 v[20:23], v2 offset:10304
    v_exp_f32 v41, v41
    v_exp_f32 v42, v42
    v_exp_f32 v43, v43
    s_waitcnt lgkmcnt(2)
    v_exp_f32 v44, v44
    v_mfma_f32_32x32x8_bf16 v[52:67], v[24:25], v[16:17], v[52:67]
    ds_read_b32 v24, v3 offset:10304
    v_exp_f32 v45, v45
    v_exp_f32 v46, v46
    v_exp_f32 v47, v47
    v_exp_f32 v48, v48
    v_smfmac_f32_32x32x32_bf16 v[68:83], v[28:31], v[36:43], v26
    ds_read_b128 v[28:31], v4 offset:10304
    v_exp_f32 v49, v49
    v_exp_f32 v50, v50
    v_exp_f32 v51, v51
    s_waitcnt lgkmcnt(2)
    s_nop 0
    v_exp_f32 v52, v52
    v_smfmac_f32_32x32x32_bf16 v[68:83], v[32:35], v[44:51], v26
    ds_read_b128 v[32:35], v5 offset:12880
    v_exp_f32 v53, v53
    v_exp_f32 v54, v54
    v_exp_f32 v55, v55
    v_exp_f32 v56, v56
    v_mfma_f32_32x32x16_bf16 v[36:51], v[20:23], v[12:15], 0
    ds_read_b128 v[20:23], v2 offset:12880
    v_exp_f32 v57, v57
    v_exp_f32 v58, v58
    v_exp_f32 v59, v59
    s_waitcnt lgkmcnt(2)
    v_exp_f32 v60, v60
    v_mfma_f32_32x32x8_bf16 v[36:51], v[24:25], v[16:17], v[36:51]
    ds_read_b32 v24, v3 offset:12880
    v_exp_f32 v61, v61
    v_exp_f32 v62, v62
    v_exp_f32 v63, v63
    v_exp_f32 v64, v64
    v_smfmac_f32_32x32x32_bf16 v[68:83], v[28:31], v[52:59], v26
    ds_read_b128 v[28:31], v4 offset:12880
    v_exp_f32 v65, v65
    v_exp_f32 v66, v66
    v_exp_f32 v67, v67
    s_waitcnt lgkmcnt(2)
    s_setprio 1
    v_exp_f32 v36, v36
    v_smfmac_f32_32x32x32_bf16 v[68:83], v[32:35], v[60:67], v26
    ds_read_b128 v[32:35], v5 offset:15456
    v_exp_f32 v37, v37
    v_exp_f32 v38, v38
    v_exp_f32 v39, v39
    v_exp_f32 v40, v40
    v_mfma_f32_32x32x16_bf16 v[52:67], v[20:23], v[12:15], 0
    ds_read_b128 v[20:23], v2 offset:15456
    v_exp_f32 v41, v41
    v_exp_f32 v42, v42
    v_exp_f32 v43, v43
    s_waitcnt lgkmcnt(2)
    v_exp_f32 v44, v44
    v_mfma_f32_32x32x8_bf16 v[52:67], v[24:25], v[16:17], v[52:67]
    ds_read_b32 v24, v3 offset:15456
    ds_read_b32 v18, v164 offset:4
    v_exp_f32 v45, v45
    v_exp_f32 v46, v46
    v_exp_f32 v47, v47
    v_exp_f32 v48, v48
    v_smfmac_f32_32x32x32_bf16 v[68:83], v[28:31], v[36:43], v26
    ds_read_b128 v[28:31], v4 offset:15456
    v_exp_f32 v49, v49
    v_exp_f32 v50, v50
    v_exp_f32 v51, v51
    s_waitcnt lgkmcnt(3)
    v_exp_f32 v52, v52
    v_smfmac_f32_32x32x32_bf16 v[68:83], v[32:35], v[44:51], v26
    ds_read_b128 v[32:35], v5 offset:18032
    v_exp_f32 v53, v53
    v_exp_f32 v54, v54
    v_exp_f32 v55, v55
    v_exp_f32 v56, v56
    v_mfma_f32_32x32x16_bf16 v[36:51], v[20:23], v[12:15], 0
    ds_read_b128 v[20:23], v2 offset:18032
    v_exp_f32 v57, v57
    v_exp_f32 v58, v58
    v_exp_f32 v59, v59
    s_waitcnt lgkmcnt(2)
    v_exp_f32 v60, v60
    v_mfma_f32_32x32x8_bf16 v[36:51], v[24:25], v[16:17], v[36:51]
    ds_read_b32 v24, v3 offset:18032
    v_exp_f32 v61, v61
    v_exp_f32 v62, v62
    v_exp_f32 v63, v63
    v_exp_f32 v64, v64
    v_smfmac_f32_32x32x32_bf16 v[68:83], v[28:31], v[52:59], v26
    ds_read_b128 v[28:31], v4 offset:18032
    v_exp_f32 v65, v65
    v_exp_f32 v66, v66
    v_exp_f32 v67, v67
    s_waitcnt lgkmcnt(2)
    v_add_u32 v4, 20608, v4
    v_add_u32 v2, 20608, v2
    v_add_u32 v3, 20608, v3
    v_add_u32 v5, 20608, v5
    v_readfirstlane_b32 s42, v18
    s_add_u32 s47, s47, 1
    s_bitcmp1_b32 s42, s47
    s_cbranch_scc0 L_edge
    s_cmp_lt_u32 s47, 7
    s_cbranch_scc1 L_loop
    buffer_load_dword v27, v27, s[24:27], s44 offen sc1
    s_setprio 3
    v_exp_f32 v36, v36
    v_smfmac_f32_32x32x32_bf16 v[68:83], v[32:35], v[60:67], v26
    ds_read_b128 v[32:35], v5 offset:0
    v_exp_f32 v37, v37
    buffer_load_dwordx4 v[84:87], v166, s[24:27], s55 offen offset:0 sc1
    v_exp_f32 v38, v38
    v_exp_f32 v39, v39
    v_exp_f32 v40, v40
    v_mfma_f32_32x32x16_bf16 v[52:67], v[20:23], v[12:15], 0
    ds_read_b128 v[20:23], v2 offset:0
    v_exp_f32 v41, v41
    buffer_load_dwordx4 v[88:91], v166, s[24:27], s55 offen offset:1024 sc1
    v_exp_f32 v42, v42
    v_exp_f32 v43, v43
    s_waitcnt lgkmcnt(2)
    v_exp_f32 v44, v44
    v_mfma_f32_32x32x8_bf16 v[52:67], v[24:25], v[16:17], v[52:67]
    ds_read_b32 v24, v3 offset:0
    v_exp_f32 v45, v45
    buffer_load_dwordx4 v[92:95], v166, s[24:27], s55 offen offset:2048 sc1
    v_exp_f32 v46, v46
    v_exp_f32 v47, v47
    v_exp_f32 v48, v48
    v_smfmac_f32_32x32x32_bf16 v[68:83], v[28:31], v[36:43], v26
    ds_read_b128 v[28:31], v4 offset:0
    v_exp_f32 v49, v49
    buffer_load_dwordx4 v[96:99], v166, s[24:27], s55 offen offset:3072 sc1
    s_add_u32 s55, s55, 4096
    v_exp_f32 v50, v50
    v_exp_f32 v51, v51
    s_waitcnt lgkmcnt(2)
    v_exp_f32 v52, v52
    v_smfmac_f32_32x32x32_bf16 v[68:83], v[32:35], v[44:51], v26
    ds_read_b128 v[32:35], v5 offset:2576
    v_exp_f32 v53, v53
    buffer_load_dwordx4 v[104:107], v166, s[24:27], s55 offen offset:0 sc1
    v_exp_f32 v54, v54
    v_exp_f32 v55, v55
    v_exp_f32 v56, v56
    v_mfma_f32_32x32x16_bf16 v[36:51], v[20:23], v[12:15], 0
    ds_read_b128 v[20:23], v2 offset:2576
    v_exp_f32 v57, v57
    buffer_load_dwordx4 v[108:111], v166, s[24:27], s55 offen offset:1024 sc1
    v_exp_f32 v58, v58
    v_exp_f32 v59, v59
    s_waitcnt lgkmcnt(2)
    v_exp_f32 v60, v60
    v_mfma_f32_32x32x8_bf16 v[36:51], v[24:25], v[16:17], v[36:51]
    ds_read_b32 v24, v3 offset:2576
    v_exp_f32 v61, v61
    buffer_load_dwordx4 v[112:115], v166, s[24:27], s55 offen offset:2048 sc1
    v_exp_f32 v62, v62
    v_exp_f32 v63, v63
    v_exp_f32 v64, v64
    v_smfmac_f32_32x32x32_bf16 v[68:83], v[28:31], v[52:59], v26
    ds_read_b128 v[28:31], v4 offset:2576
    v_exp_f32 v65, v65
    buffer_load_dwordx4 v[116:119], v166, s[24:27], s55 offen offset:3072 sc1
    s_add_u32 s55, s55, 4096
    v_exp_f32 v66, v66
    v_exp_f32 v67, v67
    s_waitcnt lgkmcnt(2)
    v_exp_f32 v36, v36
    v_smfmac_f32_32x32x32_bf16 v[68:83], v[32:35], v[60:67], v26
    ds_read_b128 v[32:35], v5 offset:5152
    v_exp_f32 v37, v37
    buffer_load_dwordx4 v[124:127], v166, s[24:27], s55 offen offset:0 sc1
    v_exp_f32 v38, v38
    v_exp_f32 v39, v39
    v_exp_f32 v40, v40
    v_mfma_f32_32x32x16_bf16 v[52:67], v[20:23], v[12:15], 0
    ds_read_b128 v[20:23], v2 offset:5152
    v_exp_f32 v41, v41
    buffer_load_dwordx4 v[128:131], v166, s[24:27], s55 offen offset:1024 sc1
    v_exp_f32 v42, v42
    v_exp_f32 v43, v43
    s_waitcnt lgkmcnt(2)
    v_exp_f32 v44, v44
    v_mfma_f32_32x32x8_bf16 v[52:67], v[24:25], v[16:17], v[52:67]
    ds_read_b32 v24, v3 offset:5152
    v_exp_f32 v45, v45
    buffer_load_dwordx4 v[132:135], v166, s[24:27], s55 offen offset:2048 sc1
    v_exp_f32 v46, v46
    v_exp_f32 v47, v47
    v_exp_f32 v48, v48
    v_smfmac_f32_32x32x32_bf16 v[68:83], v[28:31], v[36:43], v26
    ds_read_b128 v[28:31], v4 offset:5152
    v_exp_f32 v49, v49
    buffer_load_dwordx4 v[136:139], v166, s[24:27], s55 offen offset:3072 sc1
    s_add_u32 s55, s55, 4096
    v_exp_f32 v50, v50
    v_exp_f32 v51, v51
    s_waitcnt lgkmcnt(2)
    s_setprio 2
    v_exp_f32 v52, v52
    v_smfmac_f32_32x32x32_bf16 v[68:83], v[32:35], v[44:51], v26
    ds_read_b128 v[32:35], v5 offset:7728
    v_exp_f32 v53, v53
    buffer_load_dwordx4 v[144:147], v166, s[24:27], s55 offen offset:0 sc1
    v_exp_f32 v54, v54
    v_exp_f32 v55, v55
    v_exp_f32 v56, v56
    v_mfma_f32_32x32x16_bf16 v[36:51], v[20:23], v[12:15], 0
    ds_read_b128 v[20:23], v2 offset:7728
    v_exp_f32 v57, v57
    buffer_load_dwordx4 v[148:151], v166, s[24:27], s55 offen offset:1024 sc1
    v_exp_f32 v58, v58
    v_exp_f32 v59, v59
    s_waitcnt lgkmcnt(2)
    v_exp_f32 v60, v60
    v_mfma_f32_32x32x8_bf16 v[36:51], v[24:25], v[16:17], v[36:51]
    ds_read_b32 v24, v3 offset:7728
    v_exp_f32 v61, v61
    buffer_load_dwordx4 v[152:155], v166, s[24:27], s55 offen offset:2048 sc1
    v_exp_f32 v62, v62
    v_exp_f32 v63, v63
    v_exp_f32 v64, v64
    v_smfmac_f32_32x32x32_bf16 v[68:83], v[28:31], v[52:59], v26
    ds_read_b128 v[28:31], v4 offset:7728
    v_exp_f32 v65, v65
    buffer_load_dwordx4 v[156:159], v166, s[24:27], s55 offen offset:3072 sc1
    s_add_u32 s55, s55, 4096
    v_exp_f32 v66, v66
    v_exp_f32 v67, v67
    s_waitcnt lgkmcnt(2)
    v_exp_f32 v36, v36
    v_smfmac_f32_32x32x32_bf16 v[68:83], v[32:35], v[60:67], v26
    ds_read_b128 v[32:35], v5 offset:10304
    v_exp_f32 v37, v37
    buffer_load_dwordx4 v[100:103], v166, s[24:27], s54 offen offset:0 sc1
    v_exp_f32 v38, v38
    v_exp_f32 v39, v39
    v_exp_f32 v40, v40
    v_mfma_f32_32x32x16_bf16 v[52:67], v[20:23], v[12:15], 0
    ds_read_b128 v[20:23], v2 offset:10304
    v_exp_f32 v41, v41
    buffer_load_dwordx4 v[120:123], v166, s[24:27], s54 offen offset:1024 sc1
    v_exp_f32 v42, v42
    v_exp_f32 v43, v43
    s_waitcnt lgkmcnt(2)
    v_exp_f32 v44, v44
    v_mfma_f32_32x32x8_bf16 v[52:67], v[24:25], v[16:17], v[52:67]
    ds_read_b32 v24, v3 offset:10304
    v_exp_f32 v45, v45
    buffer_load_dwordx4 v[140:143], v166, s[24:27], s54 offen offset:2048 sc1
    v_exp_f32 v46, v46
    v_exp_f32 v47, v47
    v_exp_f32 v48, v48
    v_smfmac_f32_32x32x32_bf16 v[68:83], v[28:31], v[36:43], v26
    ds_read_b128 v[28:31], v4 offset:10304
    v_exp_f32 v49, v49
    buffer_load_dwordx4 v[160:163], v166, s[24:27], s54 offen offset:3072 sc1
    v_exp_f32 v50, v50
    v_exp_f32 v51, v51
    s_waitcnt lgkmcnt(2)
    v_exp_f32 v52, v52
    v_smfmac_f32_32x32x32_bf16 v[68:83], v[32:35], v[44:51], v26
    ds_read_b128 v[32:35], v5 offset:12880
    v_exp_f32 v53, v53
    s_mov_b64 exec, s[64:65]
    ds_add_u32 v164, v165 offset:20
    s_mov_b64 exec, -1
    v_exp_f32 v54, v54
    v_exp_f32 v55, v55
    v_exp_f32 v56, v56
    v_mfma_f32_32x32x16_bf16 v[36:51], v[20:23], v[12:15], 0
    ds_read_b128 v[20:23], v2 offset:12880
    v_exp_f32 v57, v57
    v_exp_f32 v58, v58
    v_exp_f32 v59, v59
    s_waitcnt lgkmcnt(2)
    v_exp_f32 v60, v60
    v_mfma_f32_32x32x8_bf16 v[36:51], v[24:25], v[16:17], v[36:51]
    ds_read_b32 v24, v3 offset:12880
    v_exp_f32 v61, v61
    v_exp_f32 v62, v62
    v_exp_f32 v63, v63
    v_exp_f32 v64, v64
    v_smfmac_f32_32x32x32_bf16 v[68:83], v[28:31], v[52:59], v26
    ds_read_b128 v[28:31], v4 offset:12880
    v_exp_f32 v65, v65
    v_exp_f32 v66, v66
    v_exp_f32 v67, v67
    s_waitcnt lgkmcnt(2)
    s_setprio 1
    v_exp_f32 v36, v36
    v_smfmac_f32_32x32x32_bf16 v[68:83], v[32:35], v[60:67], v26
    ds_read_b128 v[32:35], v5 offset:15456
    v_exp_f32 v37, v37
    v_exp_f32 v38, v38
    v_exp_f32 v39, v39
    v_exp_f32 v40, v40
    v_mfma_f32_32x32x16_bf16 v[52:67], v[20:23], v[12:15], 0
    v_exp_f32 v41, v41
    v_exp_f32 v42, v42
    v_exp_f32 v43, v43
    s_waitcnt lgkmcnt(1)
    v_exp_f32 v44, v44
    v_mfma_f32_32x32x8_bf16 v[52:67], v[24:25], v[16:17], v[52:67]
    v_exp_f32 v45, v45
    v_exp_f32 v46, v46
    v_exp_f32 v47, v47
    v_exp_f32 v48, v48
    v_smfmac_f32_32x32x32_bf16 v[68:83], v[28:31], v[36:43], v26
    ds_read_b128 v[28:31], v4 offset:15456
    v_exp_f32 v49, v49
    v_exp_f32 v50, v50
    v_exp_f32 v51, v51
    s_waitcnt lgkmcnt(1)
    s_nop 1
    v_exp_f32 v52, v52
    v_smfmac_f32_32x32x32_bf16 v[68:83], v[32:35], v[44:51], v26
    ds_read_b128 v[32:35], v5 offset:18032
    v_exp_f32 v53, v53
    v_exp_f32 v54, v54
    v_exp_f32 v55, v55
    v_exp_f32 v56, v56
    v_exp_f32 v57, v57
    v_exp_f32 v58, v58
    v_exp_f32 v59, v59
    s_waitcnt lgkmcnt(1)
    v_exp_f32 v60, v60
    v_exp_f32 v61, v61
    v_exp_f32 v62, v62
    v_exp_f32 v63, v63
    v_exp_f32 v64, v64
    v_smfmac_f32_32x32x32_bf16 v[68:83], v[28:31], v[52:59], v26
    v_exp_f32 v65, v65
    v_exp_f32 v66, v66
    v_exp_f32 v67, v67
    s_waitcnt lgkmcnt(0)
    s_nop 0
    v_smfmac_f32_32x32x32_bf16 v[68:83], v[32:35], v[60:67], v26
L_out:
    v_lshlrev_b32 v8, 4, v1
    v_lshlrev_b32 v9, 3, v1
    v_mov_b32 v10, 0x7b000000
    s_nop 8
    v_rcp_f32 v6, v80
    v_pk_add_f32 v[36:37], v[68:69], v[70:71]
    v_pk_add_f32 v[38:39], v[72:73], v[74:75]
    v_pk_add_f32 v[40:41], v[76:77], v[78:79]
    s_waitcnt vmcnt(20)
    v_mul_f32 v6, v6, v27
    v_pk_add_f32 v[36:37], v[36:37], v[38:39]
    v_mov_b32 v7, v6
    v_pk_add_f32 v[36:37], v[36:37], v[40:41]
    v_pk_mul_f32 v[68:69], v[68:69], v[6:7]
    v_pk_mul_f32 v[70:71], v[70:71], v[6:7]
    v_pk_mul_f32 v[72:73], v[72:73], v[6:7]
    v_pk_mul_f32 v[74:75], v[74:75], v[6:7]
    v_pk_mul_f32 v[76:77], v[76:77], v[6:7]
    v_pk_mul_f32 v[78:79], v[78:79], v[6:7]
    v_add_f32 v36, |v36|, |v37|
    v_add_f32 v36, v36, |v80|
    v_cmp_nlt_f32 vcc, v36, v10
    v_cvt_pk_bf16_f32 v68, v68, v69
    v_cvt_pk_bf16_f32 v69, v70, v71
    v_cvt_pk_bf16_f32 v70, v72, v73
    v_cvt_pk_bf16_f32 v71, v74, v75
    v_cvt_pk_bf16_f32 v72, v76, v77
    v_cvt_pk_bf16_f32 v73, v78, v79
    s_and_b64 vcc, vcc, s[62:63]
    s_cbranch_scc1 L_slow
    v_min_u32 v68, -2, v68
    v_min_u32 v69, -2, v69
    v_min_u32 v70, -2, v70
    v_min_u32 v71, -2, v71
    buffer_store_dwordx4 v[68:71], v8, s[24:27], s56 offen sc1
    v_min_u32 v72, -2, v72
    v_min_u32 v73, -2, v73
    s_mov_b32 exec_hi, 0
    buffer_store_dwordx2 v[72:73], v9, s[24:27], s57 offen sc1
    s_mov_b32 exec_hi, -1
    s_setprio 0
    s_lshl_b32 s42, s60, 12
    s_add_u32 s42, s42, 49152
    v_add_u32 v2, s42, v8
    s_lshl_b32 s42, s60, 10
    s_add_u32 s42, s42, 81920
    v_add_u32 v3, s42, v9
    s_mul_i32 s42, s60, 6144
    s_lshr_b32 s43, s41, 1
    s_lshl_b32 s43, s43, 10
    s_add_u32 s43, s43, s42
    v_add_u32 v4, s43, v8
    s_lshr_b32 s43, s41, 2
    s_mul_i32 s43, s43, 12288
    s_bfe_u32 s44, s41, 0x10001
    s_lshl_b32 s44, s44, 11
    s_add_u32 s43, s43, s44
    s_add_u32 s43, s43, 4096
    s_add_u32 s44, s43, s42
    v_add_u32 v5, s44, v8
    s_sub_u32 s44, s43, s42
    s_add_u32 s44, s44, 24576
    v_add_u32 v10, s44, v8
    v_and_b32 v11, 31, v1
    v_mul_u32_u24 v11, 1280, v11
    v_lshrrev_b32 v6, 5, v1
    v_lshl_add_u32 v11, v6, 4, v11
    v_mov_b32 v36, 0
    v_mov_b32 v37, 0
    v_mov_b32 v38, 0
    v_mov_b32 v39, 0
    v_mov_b32 v40, 0
    v_mov_b32 v41, 0
    v_mov_b32 v42, 0
    v_mov_b32 v43, 0
    v_mov_b32 v44, 0
    v_mov_b32 v45, 0
    v_mov_b32 v46, 0
    v_mov_b32 v47, 0
    v_mov_b32 v48, 0
    v_mov_b32 v49, 0
    v_mov_b32 v50, 0
    v_mov_b32 v51, 0
    s_mov_b32 s58, 15
    s_mov_b32 s46, 0x80000
    s_waitcnt vmcnt(2)
L_ev:
    ds_read_b32 v6, v164 offset:24
    s_waitcnt lgkmcnt(0)
    v_readfirstlane_b32 s59, v6
    s_lshr_b32 s59, s59, s60
    s_and_b32 s59, s59, s58
    s_cbranch_scc1 L_work
    s_sleep 2
    s_sub_u32 s46, s46, 1
    s_cmp_lg_u32 s46, 0
    s_cbranch_scc1 L_ev
    s_branch L_fin
L_work:
    s_bitcmp1_b32 s59, 0
    s_cbranch_scc0 L_r0
    ds_read_b128 v[52:55], v2 offset:0
    ds_read_b128 v[56:59], v2 offset:1024
    ds_read_b128 v[60:63], v2 offset:2048
    ds_read_b128 v[64:67], v2 offset:3072
    ds_read2st64_b64 v[68:71], v3 offset0:0 offset1:1
L_r0:
    s_bitcmp1_b32 s59, 1
    s_cbranch_scc0 L_r1
    ds_read_b128 v[12:15], v2 offset:4096
    ds_read_b128 v[16:19], v2 offset:5120
    ds_read_b128 v[20:23], v2 offset:6144
    ds_read_b128 v[24:27], v2 offset:7168
    ds_read2st64_b64 v[28:31], v3 offset0:2 offset1:3
L_r1:
    s_waitcnt lgkmcnt(0)
    s_bitcmp1_b32 s59, 0
    s_cbranch_scc0 L_m0
    v_mfma_f32_32x32x16_bf16 v[36:51], v[84:87], v[52:55], v[36:51]
    v_mfma_f32_32x32x16_bf16 v[36:51], v[88:91], v[56:59], v[36:51]
    v_mfma_f32_32x32x16_bf16 v[36:51], v[92:95], v[60:63], v[36:51]
    v_mfma_f32_32x32x16_bf16 v[36:51], v[96:99], v[64:67], v[36:51]
    v_mfma_f32_32x32x16_bf16 v[36:51], v[100:103], v[68:71], v[36:51]
L_m0:
    s_bitcmp1_b32 s59, 2
    s_cbranch_scc0 L_r2
    ds_read_b128 v[52:55], v2 offset:8192
    ds_read_b128 v[56:59], v2 offset:9216
    ds_read_b128 v[60:63], v2 offset:10240
    ds_read_b128 v[64:67], v2 offset:11264
    ds_read2st64_b64 v[68:71], v3 offset0:4 offset1:5
L_r2:
    s_bitcmp1_b32 s59, 1
    s_cbranch_scc0 L_m1
    v_mfma_f32_32x32x16_bf16 v[36:51], v[104:107], v[12:15], v[36:51]
    v_mfma_f32_32x32x16_bf16 v[36:51], v[108:111], v[16:19], v[36:51]
    v_mfma_f32_32x32x16_bf16 v[36:51], v[112:115], v[20:23], v[36:51]
    v_mfma_f32_32x32x16_bf16 v[36:51], v[116:119], v[24:27], v[36:51]
    v_mfma_f32_32x32x16_bf16 v[36:51], v[120:123], v[28:31], v[36:51]
L_m1:
    s_waitcnt lgkmcnt(0)
    s_bitcmp1_b32 s59, 3
    s_cbranch_scc0 L_r3
    ds_read_b128 v[12:15], v2 offset:12288
    ds_read_b128 v[16:19], v2 offset:13312
    ds_read_b128 v[20:23], v2 offset:14336
    ds_read_b128 v[24:27], v2 offset:15360
    ds_read2st64_b64 v[28:31], v3 offset0:6 offset1:7
L_r3:
    s_bitcmp1_b32 s59, 2
    s_cbranch_scc0 L_m2
    v_mfma_f32_32x32x16_bf16 v[36:51], v[124:127], v[52:55], v[36:51]
    v_mfma_f32_32x32x16_bf16 v[36:51], v[128:131], v[56:59], v[36:51]
    v_mfma_f32_32x32x16_bf16 v[36:51], v[132:135], v[60:63], v[36:51]
    v_mfma_f32_32x32x16_bf16 v[36:51], v[136:139], v[64:67], v[36:51]
    v_mfma_f32_32x32x16_bf16 v[36:51], v[140:143], v[68:71], v[36:51]
L_m2:
    s_waitcnt lgkmcnt(0)
    s_bitcmp1_b32 s59, 3
    s_cbranch_scc0 L_m3
    v_mfma_f32_32x32x16_bf16 v[36:51], v[144:147], v[12:15], v[36:51]
    v_mfma_f32_32x32x16_bf16 v[36:51], v[148:151], v[16:19], v[36:51]
    v_mfma_f32_32x32x16_bf16 v[36:51], v[152:155], v[20:23], v[36:51]
    v_mfma_f32_32x32x16_bf16 v[36:51], v[156:159], v[24:27], v[36:51]
    v_mfma_f32_32x32x16_bf16 v[36:51], v[160:163], v[28:31], v[36:51]
L_m3:
    s_andn2_b32 s58, s58, s59
    s_cbranch_scc1 L_ev
L_fin:
    ds_read_b128 v[72:75], v4
    ds_read_b128 v[76:79], v4 offset:12288
    s_nop 7
    ds_write_b128 v5, v[44:47]
    ds_write_b128 v5, v[48:51] offset:1024
    s_waitcnt lgkmcnt(0)
    s_barrier
    ds_read_b128 v[12:15], v10
    ds_read_b128 v[16:19], v10 offset:1024
    v_pk_add_f32 v[36:37], v[36:37], v[72:73]
    v_pk_add_f32 v[38:39], v[38:39], v[74:75]
    v_pk_add_f32 v[40:41], v[40:41], v[76:77]
    v_pk_add_f32 v[42:43], v[42:43], v[78:79]
    s_waitcnt lgkmcnt(0)
    v_pk_add_f32 v[36:37], v[36:37], v[12:13]
    v_pk_add_f32 v[38:39], v[38:39], v[14:15]
    v_pk_add_f32 v[40:41], v[40:41], v[16:17]
    v_pk_add_f32 v[42:43], v[42:43], v[18:19]
    v_cvt_pk_bf16_f32 v36, v36, v37
    v_cvt_pk_bf16_f32 v37, v38, v39
    v_cvt_pk_bf16_f32 v38, v40, v41
    v_cvt_pk_bf16_f32 v39, v42, v43
    s_nop 0
    v_permlane32_swap_b32 v36, v38
    v_permlane32_swap_b32 v37, v39
    buffer_store_dwordx4 v[36:39], v11, s[28:31], s61 offen
    s_endpgm
L_hpub:
    s_cmp_lg_u32 s95, 0
    s_cbranch_scc1 L_hno
    s_mov_b32 s46, 0x40000
L_poll20:
    ds_read_b32 v6, v164 offset:28
    s_waitcnt lgkmcnt(0)
    v_readfirstlane_b32 s42, v6
    s_cmp_eq_u32 s42, 1
    s_cbranch_scc1 L_got20
    s_sleep 1
    s_sub_u32 s46, s46, 1
    s_cmp_lg_u32 s46, 0
    s_cbranch_scc1 L_poll20
L_got20:
    buffer_load_dwordx4 v[12:15], v2, s[24:27], s94 offen sc1
    buffer_load_dwordx4 v[20:23], v2, s[24:27], s51 offen sc1
    buffer_load_dword v16, v3, s[24:27], s94 offen sc1
    buffer_load_dword v24, v3, s[24:27], s51 offen sc1
    s_waitcnt vmcnt(0)
L_hno:
    s_waitcnt vmcnt(6)
    s_branch L_first
L_hook:
    s_cmp_eq_u32 s47, 1
    s_cbranch_scc1 L_hfill
    s_cmp_eq_u32 s96, 0
    s_cbranch_scc1 L_hret
    s_waitcnt vmcnt(0)
    s_mov_b64 exec, s[96:97]
    buffer_store_byte v165, v19, s[24:27], 0 offen sc1
    s_mov_b64 exec, -1
    s_branch L_hret
L_hfill:
    v_mov_b32 v84, -1
    v_mov_b32 v85, -1
    v_mov_b32 v86, -1
    v_mov_b32 v87, -1
    v_lshlrev_b32 v88, 4, v1
    buffer_store_dwordx4 v[84:87], v88, s[24:27], s56 offen sc1
    s_mov_b64 exec, 0xffff
    buffer_store_dwordx4 v[84:87], v88, s[24:27], s57 offen sc1
    s_mov_b64 exec, -1
    s_mov_b32 s96, 1
    s_branch L_hret
L_edge:
    s_cmp_eq_u32 s47, 5
    s_cbranch_scc1 L_release
    s_mov_b32 s46, 0x40000
L_poll21:
    ds_read_b32 v6, v164 offset:4
    s_waitcnt lgkmcnt(0)
    v_readfirstlane_b32 s42, v6
    s_bitcmp1_b32 s42, s47
    s_cbranch_scc1 L_got21
    s_sleep 1
    s_sub_u32 s46, s46, 1
    s_cmp_lg_u32 s46, 0
    s_cbranch_scc1 L_poll21
L_got21:
    s_branch L_loop
L_release:
    s_waitcnt lgkmcnt(0)
    s_mov_b64 exec, 1
    ds_add_u32 v164, v165 offset:12
    s_mov_b64 exec, -1
    s_waitcnt lgkmcnt(0)
    s_branch L_loop
L_slow:
    s_mov_b64 s[62:63], 0
    s_waitcnt vmcnt(0)
    v_and_b32 v6, 31, v1
    v_lshrrev_b32 v7, 5, v1
    v_lshlrev_b32 v2, 4, v1
    v_and_b32 v3, 24, v6
    v_lshlrev_b32 v3, 3, v3
    v_and_b32 v8, 3, v6
    v_lshl_add_u32 v3, v8, 4, v3
    v_and_b32 v8, 4, v6
    v_lshl_add_u32 v3, v8, 1, v3
    v_lshl_add_u32 v3, v7, 2, v3
    v_add_u32 v3, 1024, v3
    v_bfe_u32 v8, v6, 2, 2
    v_xor_b32 v8, v8, v7
    v_lshlrev_b32 v8, 4, v8
    v_lshl_add_u32 v8, v6, 6, v8
    v_xor_b32 v9, 32, v8
    v_add_u32 v8, 1280, v8
    v_add_u32 v9, 1280, v9
    v_cmp_gt_u32 vcc, 20, v6
    s_nop 1
    v_cndmask_b32 v4, 0, v8, vcc
    v_cndmask_b32 v5, 0, v9, vcc
    v_mov_b32 v17, 0
    v_mov_b32 v11, 0xff800000
    s_mov_b32 s47, 0
    s_mov_b32 s50, s51
L_maxloop:
    buffer_load_dwordx4 v[20:23], v2, s[24:27], s50 offen sc1
    buffer_load_dword v24, v3, s[24:27], s50 offen sc1
    s_waitcnt vmcnt(0)
    v_mfma_f32_32x32x16_bf16 v[36:51], v[20:23], v[12:15], 0
    v_mfma_f32_32x32x8_bf16 v[36:51], v[24:25], v[16:17], v[36:51]
    s_nop 11
    v_max3_f32 v11, v11, v36, v37
    v_max3_f32 v11, v11, v38, v39
    v_max3_f32 v11, v11, v40, v41
    v_max3_f32 v11, v11, v42, v43
    v_max3_f32 v11, v11, v44, v45
    v_max3_f32 v11, v11, v46, v47
    v_max3_f32 v11, v11, v48, v49
    v_max3_f32 v11, v11, v50, v51
    s_add_u32 s50, s50, 2560
    s_add_u32 s47, s47, 1
    s_cmp_lt_u32 s47, 64
    s_cbranch_scc1 L_maxloop
    v_mov_b32 v6, v11
    s_nop 1
    v_permlane32_swap_b32 v11, v6
    v_max_f32 v11, v11, v6
    v_cvt_pk_bf16_f32 v11, -v11, 0
    v_cmp_gt_u32 vcc, 32, v1
    s_nop 1
    v_cndmask_b32 v17, 0, v11, vcc
    v_mov_b32 v68, 0
    v_mov_b32 v69, 0
    v_mov_b32 v70, 0
    v_mov_b32 v71, 0
    v_mov_b32 v72, 0
    v_mov_b32 v73, 0
    v_mov_b32 v74, 0
    v_mov_b32 v75, 0
    v_mov_b32 v76, 0
    v_mov_b32 v77, 0
    v_mov_b32 v78, 0
    v_mov_b32 v79, 0
    v_mov_b32 v80, 0
    v_mov_b32 v81, 0
    v_mov_b32 v82, 0
    v_mov_b32 v83, 0
    v_mov_b32 v28, 0x3f803f80
    v_mov_b32 v29, 0x3f803f80
    v_mov_b32 v30, 0x3f803f80
    v_mov_b32 v31, 0x3f803f80
    v_mov_b32 v32, 0x3f803f80
    v_mov_b32 v33, 0x3f803f80
    v_mov_b32 v34, 0x3f803f80
    v_mov_b32 v35, 0x3f803f80
    s_mov_b32 s47, 0
    s_mov_b32 s50, s51
L_slowloop:
    buffer_load_dwordx4 v[20:23], v2, s[24:27], s50 offen sc1
    buffer_load_dword v24, v3, s[24:27], s50 offen sc1
    s_mov_b32 exec_lo, 0xfffff
    s_mov_b32 exec_hi, 0xfffff
    buffer_load_dwordx4 v[28:31], v4, s[24:27], s50 offen sc1
    buffer_load_dwordx4 v[32:35], v5, s[24:27], s50 offen sc1
    s_mov_b64 exec, -1
    s_waitcnt vmcnt(0)
    v_mfma_f32_32x32x16_bf16 v[36:51], v[20:23], v[12:15], 0
    v_mfma_f32_32x32x8_bf16 v[36:51], v[24:25], v[16:17], v[36:51]
    s_nop 11
    v_exp_f32 v36, v36
    v_exp_f32 v37, v37
    v_exp_f32 v38, v38
    v_exp_f32 v39, v39
    v_exp_f32 v40, v40
    v_exp_f32 v41, v41
    v_exp_f32 v42, v42
    v_exp_f32 v43, v43
    v_exp_f32 v44, v44
    v_exp_f32 v45, v45
    v_exp_f32 v46, v46
    v_exp_f32 v47, v47
    v_exp_f32 v48, v48
    v_exp_f32 v49, v49
    v_exp_f32 v50, v50
    v_exp_f32 v51, v51
    v_smfmac_f32_32x32x32_bf16 v[68:83], v[28:31], v[36:43], v26
    s_nop 0
    v_smfmac_f32_32x32x32_bf16 v[68:83], v[32:35], v[44:51], v26
    s_add_u32 s50, s50, 2560
    s_add_u32 s47, s47, 1
    s_cmp_lt_u32 s47, 64
    s_cbranch_scc1 L_slowloop
    s_nop 7
    s_nop 7
    s_branch L_out
L_end:
    s_endpgm
.section .rodata,"a"
.p2align 6
.amdhsa_kernel gm_fused_kernel
  .amdhsa_next_free_vgpr 168
  .amdhsa_next_free_sgpr 102
  .amdhsa_accum_offset 168
  .amdhsa_group_segment_fixed_size 0
  .amdhsa_kernarg_size 80
  .amdhsa_user_sgpr_count 2
  .amdhsa_user_sgpr_kernarg_segment_ptr 1
  .amdhsa_system_sgpr_workgroup_id_x 1
.end_amdhsa_kernel
```
